```python
import torch

def _softmax(x, axis=-1):
    return torch.softmax(x, dim=axis)
def _gelu(x):
    return torch.nn.functional.gelu(x, approximate="tanh")
def _silu(x):
    return torch.nn.functional.silu(x)
def _sigmoid(x):
    return torch.sigmoid(x)
def _layernorm(x, axis=-1, eps=1e-5):
    m = x.mean(dim=axis, keepdim=True)
    v = x.var(dim=axis, keepdim=True, unbiased=False)
    return (x - m) / torch.sqrt(v + eps)
def _scatter_add(tgt, idx, src, axis=0):
    return tgt.clone().index_add_(axis, idx, src)
def _segment_sum(src, seg, n):
    out = torch.zeros((n,) + src.shape[1:], dtype=src.dtype)
    return out.index_add_(0, seg, src)
def _pad(x, pw):
    flat = tuple(v for pair in reversed(pw) for v in pair)
    return torch.nn.functional.pad(x, flat)

kernel_name = 'parallel_sum__mha_block__geglu_ffn__prompt'

def setup_inputs():

    _w = (lambda a: (lambda t: t.to(torch.bfloat16) if t.is_floating_point() else t)(torch.as_tensor(a)))
    def _A_setup():
        B, S, D, H = 1, 2048, 448, 16
        return {
            "x": _w((lambda *s: torch.randn(*s, dtype=torch.bfloat16) * 0.05)(B, S, D)),
            "wqkv": _w((lambda *s: torch.randn(*s, dtype=torch.bfloat16) * 0.2)(D, 3 * D)),
            "wo": _w((lambda *s: torch.randn(*s, dtype=torch.bfloat16) * 0.1)(D, D)),
        }
    _A_in = _A_setup()

    def _B_setup():
        B, S, D, F = 1, 2048, 448, 1792
        return {
            "x": _w((lambda *s: torch.randn(*s, dtype=torch.bfloat16) * 0.05)(B, S, D)),
            "w_gate": _w((lambda *s: torch.randn(*s, dtype=torch.bfloat16) * 0.1)(D, F)),
            "w_up": _w((lambda *s: torch.randn(*s, dtype=torch.bfloat16) * 0.1)(D, F)),
            "w_down": _w((lambda *s: torch.randn(*s, dtype=torch.bfloat16) * 0.1)(F, D)),
        }
    _B_in = _B_setup()

    return {
        "A_x": _A_in["x"],
        "A_wqkv": _A_in["wqkv"],
        "A_wo": _A_in["wo"],
        "B_x": _B_in["x"],
        "B_w_gate": _B_in["w_gate"],
        "B_w_up": _B_in["w_up"],
        "B_w_down": _B_in["w_down"],
    }

def reference(A_x, A_wqkv, A_wo, B_x, B_w_gate, B_w_up, B_w_down):
    def _A_ref(x, wqkv, wo):
        B, S, D = x.shape
        H = 16
        Dh = D // H
        qkv = (lambda x, *d: x.permute(*d))((x @ wqkv).reshape(B, S, 3, H, Dh), 2, 0, 3, 1, 4)
        q, k, v = qkv[0], qkv[1], qkv[2]
        scores = torch.einsum("bhqd,bhkd->bhqk", q, k) * (Dh ** -0.5)
        p = _softmax(scores, axis=-1)
        o = torch.einsum("bhqk,bhkd->bhqd", p, v)
        return (lambda x, *d: x.permute(*d))(o, 0, 2, 1, 3).reshape(B, S, D) @ wo

    def _B_ref(x, w_gate, w_up, w_down):
        return (_gelu(x @ w_gate) * (x @ w_up)) @ w_down

    x = A_x
    xn = _layernorm(x, axis=-1)
    return x + _A_ref(xn, A_wqkv, A_wo) + _B_ref(xn, B_w_gate, B_w_up, B_w_down)
```

```asm
; @launch grid=(256,1,1) block=(512,1,1) lds=163840
.amdgcn_target "amdgcn-amd-amdhsa--gfx950"
.text
.p2align 8
.globl parallel_sum__mha_block__geglu_ffn__prompt_kernel
.type parallel_sum__mha_block__geglu_ffn__prompt_kernel,@function
parallel_sum__mha_block__geglu_ffn__prompt_kernel:
    s_cmp_ge_u32 s2, 256
    s_cbranch_scc1 L_END
    s_setprio 3
    s_load_dwordx16 s[4:19], s[0:1], 0
    s_load_dwordx4 s[20:23], s[0:1], 64
    s_getpc_b64 s[94:95]
    s_lshr_b32 s86, s2, 3
    s_mul_i32 s86, s86, 9
    v_min_u32 v1, 8, v0
    v_add_u32 v1, s86, v1
    v_min_u32 v1, 0x110, v1
    v_lshlrev_b32 v1, 7, v1
    v_cmp_gt_u32 vcc, 64, v0
    s_cbranch_vccz L_NOCPF1
    global_load_dword v216, v1, s[94:95]
L_NOCPF1:
    v_lshrrev_b32 v1, 6, v0
    v_and_b32 v0, 63, v0
    s_and_b32 s86, s2, 1
    v_readfirstlane_b32 s62, v1
    s_lshl_b32 s86, s86, 3
    s_bfe_u32 s60, s2, 0x30003
    s_add_u32 s60, s60, s86
    s_bfe_u32 s97, s2, 0x20001
    s_lshr_b32 s86, s2, 6
    s_lshl_b32 s61, s97, 2
    s_add_u32 s61, s61, s86
    s_bitcmp1_b32 s97, 0
    s_cselect_b32 s100, 0, 3
    s_xor_b32 s100, s100, s61
    v_lshrrev_b32 v192, 3, v0
    v_and_b32 v193, 7, v0
    v_lshrrev_b32 v194, 4, v0
    s_and_b32 s79, s62, 1
    s_lshl_b32 s86, s79, 2
    v_or_b32 v195, s86, v194
    v_xor_b32 v195, v195, v193
    v_mul_u32_u24 v196, 896, v192
    v_lshl_add_u32 v2, v195, 4, v196
    s_lshl_b32 s86, s60, 4
    s_add_u32 s86, s86, s62
    s_mul_i32 s91, s86, 7168
    s_lshl_b32 s65, s62, 10
    s_lshr_b32 s63, s62, 2
    s_and_b32 s64, s62, 3
    s_mul_i32 s66, s100, 112
    s_mul_i32 s86, s62, 21504
    s_add_u32 s66, s66, s86
    v_and_b32 v197, 1, v194
    v_lshlrev_b32 v197, 2, v197
    v_xor_b32 v197, v197, v193
    v_lshlrev_b32 v197, 4, v197
    v_mul_u32_u24 v3, 2688, v192
    v_min_u32 v198, 0x60, v197
    v_add_u32 v3, v3, v198
    v_and_b32 v198, 15, v0
    v_lshlrev_b32 v199, 2, v194
    v_xor_b32 v198, v198, v199
    v_min_u32 v198, 13, v198
    v_mul_u32_u24 v4, 2688, v194
    v_lshl_add_u32 v4, v198, 4, v4
    v_mul_u32_u24 v251, 3584, v192
    v_add_u32 v251, v251, v197
    v_add_u32 v6, v196, v197
    s_bfe_u32 s88, s62, 0x10001
    s_lshl_b32 s87, s63, 1
    s_add_u32 s86, s79, s87
    s_mul_i32 s69, s86, 28672
    s_lshl_b32 s87, s61, 7
    s_add_u32 s67, s69, s87
    s_add_u32 s69, s67, 1536
    s_lshl_b32 s87, s97, 7
    s_sub_u32 s67, s67, s87
    s_mul_i32 s86, s62, 10752
    s_mul_i32 s87, s97, 224
    s_add_u32 s86, s86, s87
    s_add_u32 s86, s86, 1792
    s_cmp_ge_u32 s2, 192
    s_cselect_b32 s67, s86, s67
    s_cselect_b64 vcc, -1, 0
    s_mov_b32 s68, 114688
    s_cselect_b32 s68, 86016, s68
    v_cndmask_b32 v4, v251, v4, vcc
    v_lshrrev_b32 v202, 2, v0
    v_xor_b32 v202, v202, v194
    v_and_b32 v202, 1, v202
    v_and_or_b32 v202, v0, 3, v202
    v_cmp_eq_u32 vcc, 0, v202
    v_mov_b32 v203, 0x3f803f80
    s_nop 0
    v_cndmask_b32 v28, 0, v203, vcc
    v_cndmask_b32 v29, 0, v203, vcc
    v_cndmask_b32 v30, 0, v203, vcc
    v_cndmask_b32 v31, 0, v203, vcc
    s_xor_b32 s96, s64, s63
    v_lshrrev_b32 v204, 5, v0
    v_and_b32 v205, 31, v0
    v_bfe_u32 v206, v0, 1, 3
    v_xor_b32 v206, v206, v204
    s_lshl_b32 s86, s96, 1
    v_xor_b32 v206, s86, v206
    s_lshl_b32 s86, s64, 12
    v_lshl_add_u32 v207, v205, 7, s86
    v_xor_b32 v208, 0, v206
    v_lshl_add_u32 v16, v208, 4, v207
    v_xor_b32 v208, 2, v206
    v_lshl_add_u32 v17, v208, 4, v207
    v_xor_b32 v208, 4, v206
    v_lshl_add_u32 v18, v208, 4, v207
    v_xor_b32 v208, 6, v206
    v_lshl_add_u32 v19, v208, 4, v207
    v_bfe_u32 v9, v0, 2, 2
    v_lshl_add_u32 v9, v204, 3, v9
    v_lshlrev_b32 v9, 7, v9
    v_and_b32 v10, 16, v0
    v_lshlrev_b32 v10, 1, v10
    v_and_b32 v11, 3, v0
    v_lshl_add_u32 v10, v11, 3, v10
    v_and_b32 v11, 8, v0
    v_lshlrev_b32 v11, 3, v11
    s_mul_i32 s86, s63, 56
    v_add_u32 v23, s86, v10
    v_xor_b32 v23, v23, v11
    v_add3_u32 v23, v23, v9, 0
    s_xor_b32 s87, s96, 0
    s_lshl_b32 s87, s87, 11
    v_add_u32 v20, s87, v23
    s_xor_b32 s87, s96, 1
    s_lshl_b32 s87, s87, 11
    v_add_u32 v21, s87, v23
    s_xor_b32 s87, s96, 2
    s_lshl_b32 s87, s87, 11
    v_add_u32 v22, s87, v23
    s_xor_b32 s87, s96, 3
    s_lshl_b32 s87, s87, 11
    v_add_u32 v23, s87, v23
    s_lshl_b32 s86, s64, 2
    s_add_u32 s86, s86, 155648
    v_lshl_add_u32 v249, v205, 4, s86
    s_lshl_b32 s86, s64, 9
    s_add_u32 s86, s86, 160768
    v_lshl_add_u32 v250, v205, 3, s86
    s_waitcnt lgkmcnt(0)
    s_mov_b32 s24, s4
    s_mov_b32 s25, s5
    s_mov_b32 s26, 0x1c0000
    s_mov_b32 s27, 0x20000
    s_add_u32 m0, s65, 0
    s_nop 0
    buffer_load_dwordx4 v2, s[24:27], s91 offen lds
    s_add_u32 m0, s65, 8192
    s_add_u32 s91, s91, 57344
    buffer_load_dwordx4 v2, s[24:27], s91 offen lds
    s_mov_b32 s28, s6
    s_mov_b32 s29, s7
    s_mov_b32 s30, 0x126000
    s_mov_b32 s31, 0x20000
    s_add_u32 m0, s65, 16384
    s_sub_u32 s91, s91, 57216
    buffer_load_dwordx4 v3, s[28:31], s66 offen lds
    s_cmp_eq_u32 s88, 1
    s_cselect_b32 s36, s14, s12
    s_cselect_b32 s37, s15, s13
    s_mov_b32 s38, 0x188000
    s_mov_b32 s39, 0x20000
    s_mov_b32 s35, 0x20000
    s_cmp_ge_u32 s2, 192
    s_cselect_b32 s32, s6, s36
    s_cselect_b32 s33, s7, s37
    s_cselect_b32 s34, 0x126000, s38
    s_add_u32 s66, s66, 172032
    s_mov_b32 s86, s61
    s_and_b32 s87, s86, 1
    s_mul_i32 s87, s87, 57344
    s_lshr_b32 s86, s86, 1
    s_min_u32 s86, s86, 5
    s_lshl_b32 s86, s86, 7
    s_add_u32 s4, s91, s87
    s_add_u32 s4, s4, s86
    s_mov_b32 s86, s60
    s_mul_i32 s87, s86, 172032
    s_add_u32 s5, s66, s87
    s_mul_i32 s87, s86, s68
    s_add_u32 s10, s67, s87
    s_mul_i32 s87, s86, 114688
    s_add_u32 s11, s69, s87
    s_add_u32 m0, s65, 24576
    s_nop 0
    buffer_load_dwordx4 v4, s[32:35], s67 offen lds
    s_add_u32 m0, s65, 32768
    s_add_u32 s67, s67, s68
    buffer_load_dwordx4 v4, s[32:35], s67 offen lds
    s_setprio 0
    s_cmp_ge_u32 s2, 192
    s_cbranch_scc1 L_VTYPE
    s_lshl_b32 s86, s63, 6
    v_add_u32 v15, s86, v10
    v_xor_b32 v15, v15, v11
    v_add3_u32 v15, v15, v9, 0
    s_xor_b32 s87, s96, 0
    s_lshl_b32 s87, s87, 12
    v_add_u32 v12, s87, v15
    s_xor_b32 s87, s96, 1
    s_lshl_b32 s87, s87, 12
    v_add_u32 v13, s87, v15
    s_xor_b32 s87, s96, 2
    s_lshl_b32 s87, s87, 12
    v_add_u32 v14, s87, v15
    s_xor_b32 s87, s96, 3
    s_lshl_b32 s87, s87, 12
    v_add_u32 v15, s87, v15
    v_mov_b32 v204, 0
    v_mov_b32 v205, 0
    v_mov_b32 v206, 0
    v_mov_b32 v207, 0
    s_lshl_b32 s87, s68, 1
    s_add_u32 s10, s10, s87
    s_cmp_lt_u32 s61, 6
    s_cselect_b32 s86, s4, 0x7ff00000
    buffer_load_dword v216, v2, s[24:27], s86 offen
    s_cmp_lt_u32 s60, 6
    s_cselect_b32 s86, s10, 0x7ff00000
    buffer_load_dword v216, v4, s[32:35], s86 offen
    s_cmp_lt_u32 s60, 3
    s_cselect_b32 s86, s5, 0x7ff00000
    buffer_load_dword v216, v3, s[28:31], s86 offen
    s_add_u32 m0, s65, 40960
    s_add_u32 s67, s67, s68
    buffer_load_dwordx4 v2, s[24:27], s91 offen lds
    s_add_u32 m0, s65, 49152
    s_add_u32 s91, s91, 57344
    buffer_load_dwordx4 v2, s[24:27], s91 offen lds
    s_add_u32 m0, s65, 57344
    s_sub_u32 s91, s91, 57216
    buffer_load_dwordx4 v3, s[28:31], s66 offen lds
    s_add_u32 m0, s65, 65536
    s_add_u32 s66, s66, 172032
    buffer_load_dwordx4 v4, s[32:35], s67 offen lds
    s_add_u32 m0, s65, 73728
    s_add_u32 s67, s67, 114688
    buffer_load_dwordx4 v4, s[32:35], s67 offen lds
    s_waitcnt vmcnt(8)
    s_barrier
    ds_read_b128 v[32:35], v16
    ds_read_b64_tr_b16 v[224:225], v20 offset:16384
    ds_read_b64_tr_b16 v[226:227], v20 offset:16896
    ds_read_b64_tr_b16 v[228:229], v12 offset:24576
    ds_read_b64_tr_b16 v[230:231], v12 offset:25088
    ds_read_b64_tr_b16 v[232:233], v12 offset:26624
    ds_read_b64_tr_b16 v[234:235], v12 offset:27136
    s_waitcnt lgkmcnt(4)
    v_mfma_f32_32x32x16_bf16 v[144:159], v[224:227], v[32:35], 0
    s_setprio 3
    ds_read_b128 v[36:39], v17
    ds_read_b64_tr_b16 v[236:237], v21 offset:16384
    ds_read_b64_tr_b16 v[238:239], v21 offset:16896
    s_add_u32 m0, s65, 81920
    s_add_u32 s67, s67, 114688
    buffer_load_dwordx4 v2, s[24:27], s91 offen lds
    s_waitcnt lgkmcnt(5)
    v_mfma_f32_32x32x16_bf16 v[160:175], v[228:231], v[32:35], 0
    ds_read_b64_tr_b16 v[240:241], v13 offset:24576
    ds_read_b64_tr_b16 v[242:243], v13 offset:25088
    s_waitcnt lgkmcnt(5)
    v_mfma_f32_32x32x16_bf16 v[176:191], v[232:235], v[32:35], 0
    ds_read_b64_tr_b16 v[244:245], v13 offset:26624
    ds_read_b64_tr_b16 v[246:247], v13 offset:27136
    s_mov_b32 s40, s22
    s_mov_b32 s41, s23
    s_mov_b32 s42, 0x1800000
    s_mov_b32 s43, 0x20000
    s_mov_b32 s44, s16
    s_mov_b32 s45, s17
    s_mov_b32 s46, 0x188000
    s_mov_b32 s47, 0x20000
    s_mov_b32 s48, s8
    s_mov_b32 s49, s9
    s_mov_b32 s50, 0x62000
    s_mov_b32 s51, 0x20000
    s_mov_b32 s52, s18
    s_mov_b32 s53, s19
    s_mov_b32 s54, 0x1c0000
    s_mov_b32 s55, 0x20000
    s_mov_b32 s56, s20
    s_mov_b32 s57, s21
    s_mov_b32 s58, 0x100
    s_mov_b32 s59, 0x20000
    v_lshlrev_b32 v1, 4, v0
    v_mfma_f32_16x16x32_bf16 v[192:195], v[28:31], v[224:227], 0
    v_lshlrev_b32 v208, 16, v32
    v_and_b32 v209, 0xffff0000, v32
    v_lshlrev_b32 v210, 16, v33
    v_and_b32 v211, 0xffff0000, v33
    v_add_f32 v204, v204, v208
    v_add_f32 v205, v205, v209
    v_fmac_f32 v206, v208, v208
    v_fmac_f32 v207, v209, v209
    v_add_f32 v204, v204, v210
    v_add_f32 v205, v205, v211
    v_fmac_f32 v206, v210, v210
    v_fmac_f32 v207, v211, v211
    s_waitcnt lgkmcnt(0)
    v_mfma_f32_32x32x16_bf16 v[144:159], v[236:239], v[36:39], v[144:159]
    s_setprio 2
    ds_read_b128 v[40:43], v18
    ds_read_b64_tr_b16 v[224:225], v22 offset:16384
    ds_read_b64_tr_b16 v[226:227], v22 offset:16896
    s_add_u32 m0, s65, 90112
    s_add_u32 s91, s91, 57344
    buffer_load_dwordx4 v2, s[24:27], s91 offen lds
    v_mfma_f32_32x32x16_bf16 v[160:175], v[240:243], v[36:39], v[160:175]
    ds_read_b64_tr_b16 v[228:229], v14 offset:24576
    ds_read_b64_tr_b16 v[230:231], v14 offset:25088
    s_add_u32 m0, s65, 98304
    s_sub_u32 s91, s91, 57216
    buffer_load_dwordx4 v3, s[28:31], s66 offen lds
    v_mfma_f32_32x32x16_bf16 v[176:191], v[244:247], v[36:39], v[176:191]
    ds_read_b64_tr_b16 v[232:233], v14 offset:26624
    ds_read_b64_tr_b16 v[234:235], v14 offset:27136
    s_sub_u32 s87, s2, 0
    s_lshl_b32 s86, s87, 3
    s_add_u32 s86, s86, s62
    s_mul_i32 s86, s86, 1024
    s_add_u32 s86, s86, 0xf00000
    s_mul_i32 s9, s87, 16
    s_cmp_lt_u32 s87, 16
    s_cselect_b32 s86, s86, 0x7ff00000
    s_cselect_b32 s9, s9, 0x1000
    v_mov_b32 v212, 0
    v_mov_b32 v213, 0
    v_mov_b32 v214, 0
    v_mov_b32 v215, 0
    s_cbranch_scc0 L_G1
    buffer_store_dwordx4 v[212:215], v1, s[40:43], s86 offen sc1
L_G1:
    v_or_b32 v222, s62, v0
    v_cmp_eq_u32 vcc, 0, v222
    v_mov_b32 v222, 0x7ffffff0
    s_nop 0
    v_cndmask_b32 v7, v222, 0, vcc
    v_cmp_lt_u32 s[92:93], 31, v0
    v_mov_b32 v248, 1
    v_mfma_f32_16x16x32_bf16 v[196:199], v[28:31], v[240:243], 0
    v_lshlrev_b32 v208, 16, v34
    v_and_b32 v209, 0xffff0000, v34
    v_lshlrev_b32 v210, 16, v35
    v_and_b32 v211, 0xffff0000, v35
    v_add_f32 v204, v204, v208
    v_add_f32 v205, v205, v209
    v_fmac_f32 v206, v208, v208
    v_fmac_f32 v207, v209, v209
    v_add_f32 v204, v204, v210
    v_add_f32 v205, v205, v211
    v_fmac_f32 v206, v210, v210
    v_fmac_f32 v207, v211, v211
    s_waitcnt lgkmcnt(0)
    v_mfma_f32_32x32x16_bf16 v[144:159], v[224:227], v[40:43], v[144:159]
    s_setprio 1
    ds_read_b128 v[44:47], v19
    ds_read_b64_tr_b16 v[236:237], v23 offset:16384
    ds_read_b64_tr_b16 v[238:239], v23 offset:16896
    s_add_u32 m0, s65, 106496
    s_add_u32 s66, s66, 172032
    buffer_load_dwordx4 v4, s[32:35], s67 offen lds
    v_mfma_f32_32x32x16_bf16 v[160:175], v[228:231], v[40:43], v[160:175]
    ds_read_b64_tr_b16 v[240:241], v15 offset:24576
    ds_read_b64_tr_b16 v[242:243], v15 offset:25088
    v_mfma_f32_32x32x16_bf16 v[176:191], v[232:235], v[40:43], v[176:191]
    ds_read_b64_tr_b16 v[244:245], v15 offset:26624
    ds_read_b64_tr_b16 v[246:247], v15 offset:27136
    s_and_b32 s86, s2, 7
    s_lshr_b32 s87, s2, 3
    s_lshl_b32 s71, s86, 1
    s_lshr_b32 s88, s87, 4
    s_add_u32 s71, s71, s88
    s_and_b32 s72, s87, 15
    s_sub_u32 s88, s87, 4
    s_cmp_ge_u32 s87, 28
    s_cselect_b32 s87, s88, s87
    s_cselect_b32 s54, 0, s54
    s_mul_i32 s76, s87, 37
    s_lshr_b32 s76, s76, 8
    s_mul_i32 s88, s76, 7
    s_sub_u32 s77, s87, s88
    s_lshl_b32 s86, s86, 2
    s_add_u32 s76, s76, s86
    v_mfma_f32_16x16x32_bf16 v[200:203], v[28:31], v[232:235], 0
    v_lshlrev_b32 v208, 16, v40
    v_and_b32 v209, 0xffff0000, v40
    v_lshlrev_b32 v210, 16, v41
    v_and_b32 v211, 0xffff0000, v41
    v_add_f32 v204, v204, v208
    v_add_f32 v205, v205, v209
    v_fmac_f32 v206, v208, v208
    v_fmac_f32 v207, v209, v209
    v_add_f32 v204, v204, v210
    v_add_f32 v205, v205, v211
    v_fmac_f32 v206, v210, v210
    v_fmac_f32 v207, v211, v211
    v_add_u32 v12, 0x10000, v12
    s_waitcnt vmcnt(4)
    s_waitcnt lgkmcnt(0)
    s_barrier
    v_mfma_f32_32x32x16_bf16 v[144:159], v[236:239], v[44:47], v[144:159]
    s_setprio 3
    ds_read_b128 v[48:51], v16 offset:40960
    ds_read_b64_tr_b16 v[224:225], v20 offset:57344
    ds_read_b64_tr_b16 v[226:227], v20 offset:57856
    s_add_u32 m0, s65, 114688
    s_add_u32 s67, s67, 114688
    buffer_load_dwordx4 v4, s[32:35], s67 offen lds
    v_mfma_f32_32x32x16_bf16 v[160:175], v[240:243], v[44:47], v[160:175]
    ds_read_b64_tr_b16 v[228:229], v12
    ds_read_b64_tr_b16 v[230:231], v12 offset:512
    s_add_u32 m0, s65, 122880
    s_add_u32 s67, s67, 114688
    buffer_load_dwordx4 v2, s[24:27], s91 offen lds
    s_sub_u32 s86, s2, 128
    s_cmp_lt_u32 s86, 32
    s_cbranch_scc0 L_Z2
    s_lshl_b32 s86, s86, 3
    s_add_u32 s86, s86, s62
    s_mul_i32 s86, s86, 7168
    v_and_b32 v217, 3, v0
    v_min_u32 v217, 2, v217
    v_lshlrev_b32 v217, 7, v217
    v_bfe_u32 v218, v0, 2, 3
    v_mul_u32_u24 v218, 896, v218
    v_add_u32 v217, v217, v218
    buffer_load_dword v216, v217, s[24:27], s86 offen offset:512
L_Z2:
    s_sub_u32 s86, s2, 160
    s_cmp_lt_u32 s86, 32
    s_cbranch_scc0 L_Z3
    s_lshl_b32 s86, s86, 3
    s_add_u32 s86, s86, s62
    s_lshl_b32 s86, s86, 11
    s_add_u32 s86, s86, 688128
    v_and_b32 v217, 15, v0
    v_lshlrev_b32 v217, 7, v217
    buffer_load_dword v216, v217, s[28:31], s86 offen
L_Z3:
    s_sub_u32 s86, s2, 192
    s_cmp_lt_u32 s86, 32
    s_cbranch_scc0 L_Z4
    s_lshl_b32 s86, s86, 2
    s_lshl_b32 s87, s63, 1
    s_add_u32 s86, s86, s87
    s_add_u32 s86, s86, s79
    s_mul_i32 s86, s86, 7168
    s_add_u32 s86, s86, 917504
    v_and_b32 v217, 15, v0
    v_min_u32 v217, 11, v217
    v_lshlrev_b32 v217, 7, v217
    v_bfe_u32 v218, v0, 4, 1
    v_mul_u32_u24 v218, 3584, v218
    v_add_u32 v217, v217, v218
    buffer_load_dword v216, v217, s[36:39], s86 offen
L_Z4:
    v_mfma_f32_32x32x16_bf16 v[176:191], v[244:247], v[44:47], v[176:191]
    ds_read_b64_tr_b16 v[232:233], v12 offset:2048
    ds_read_b64_tr_b16 v[234:235], v12 offset:2560
    s_lshr_b32 s78, s62, 1
    s_lshl_b32 s70, s60, 2
    s_add_u32 s70, s70, s64
    s_lshl_b32 s82, s72, 2
    s_add_u32 s82, s82, s64
    s_lshl_b32 s81, s71, 18
    s_add_u32 s81, s81, 0x200000
    s_add_u32 s73, s81, s65
    s_mul_i32 s74, s78, 172032
    s_mul_i32 s86, s79, 7168
    s_add_u32 s74, s74, s86
    s_lshl_b32 s86, s77, 7
    s_add_u32 s74, s74, s86
    s_cmp_ge_u32 s2, 224
    s_cselect_b32 s74, 0x70000000, s74
    v_lshlrev_b32 v208, 16, v42
    v_and_b32 v209, 0xffff0000, v42
    v_lshlrev_b32 v210, 16, v43
    v_and_b32 v211, 0xffff0000, v43
    v_add_f32 v204, v204, v208
    v_add_f32 v205, v205, v209
    v_fmac_f32 v206, v208, v208
    v_fmac_f32 v207, v209, v209
    v_add_f32 v204, v204, v210
    v_add_f32 v205, v205, v211
    v_fmac_f32 v206, v210, v210
    v_fmac_f32 v207, v211, v211
    v_add_u32 v13, 0x10000, v13
    s_waitcnt lgkmcnt(0)
    v_mfma_f32_32x32x16_bf16 v[144:159], v[224:227], v[48:51], v[144:159]
    s_setprio 2
    ds_read_b128 v[52:55], v17 offset:40960
    ds_read_b64_tr_b16 v[236:237], v21 offset:57344
    ds_read_b64_tr_b16 v[238:239], v21 offset:57856
    s_add_u32 m0, s65, 131072
    s_add_u32 s91, s91, 57344
    buffer_load_dwordx4 v2, s[24:27], s91 offen lds
    v_mfma_f32_32x32x16_bf16 v[160:175], v[228:231], v[48:51], v[160:175]
    ds_read_b64_tr_b16 v[240:241], v13
    ds_read_b64_tr_b16 v[242:243], v13 offset:512
    v_mfma_f32_32x32x16_bf16 v[176:191], v[232:235], v[48:51], v[176:191]
    ds_read_b64_tr_b16 v[244:245], v13 offset:2048
    ds_read_b64_tr_b16 v[246:247], v13 offset:2560
    s_lshl_b32 s86, s100, 4
    s_add_u32 s86, s86, s60
    s_lshl_b32 s86, s86, 2
    s_add_u32 s83, s86, 0x0
    s_lshl_b32 s87, s97, 4
    s_add_u32 s87, s87, s60
    s_lshl_b32 s87, s87, 2
    s_add_u32 s87, s87, 0x400
    s_lshl_b32 s86, s60, 5
    s_add_u32 s86, s86, s61
    s_lshl_b32 s86, s86, 2
    s_add_u32 s85, s86, 0x830
    s_lshl_b32 s84, s97, 2
    s_sub_u32 s84, s85, s84
    s_sub_u32 s84, s84, 48
    s_cmp_ge_u32 s2, 192
    s_cselect_b32 s84, s87, s84
    v_mfma_f32_16x16x32_bf16 v[192:195], v[28:31], v[224:227], v[192:195]
    v_lshlrev_b32 v208, 16, v48
    v_and_b32 v209, 0xffff0000, v48
    v_lshlrev_b32 v210, 16, v49
    v_and_b32 v211, 0xffff0000, v49
    v_add_f32 v204, v204, v208
    v_add_f32 v205, v205, v209
    v_fmac_f32 v206, v208, v208
    v_fmac_f32 v207, v209, v209
    v_add_f32 v204, v204, v210
    v_add_f32 v205, v205, v211
    v_fmac_f32 v206, v210, v210
    v_fmac_f32 v207, v211, v211
    v_add_u32 v14, 0x10000, v14
    s_waitcnt lgkmcnt(0)
    v_mfma_f32_32x32x16_bf16 v[144:159], v[236:239], v[52:55], v[144:159]
    s_setprio 1
    ds_read_b128 v[56:59], v18 offset:40960
    ds_read_b64_tr_b16 v[224:225], v22 offset:57344
    ds_read_b64_tr_b16 v[226:227], v22 offset:57856
    s_add_u32 m0, s65, 139264
    s_sub_u32 s91, s91, 57216
    buffer_load_dwordx4 v3, s[28:31], s66 offen lds
    v_mfma_f32_32x32x16_bf16 v[160:175], v[240:243], v[52:55], v[160:175]
    ds_read_b64_tr_b16 v[228:229], v14
    ds_read_b64_tr_b16 v[230:231], v14 offset:512
    s_add_u32 m0, s65, 147456
    s_add_u32 s66, s66, 172032
    buffer_load_dwordx4 v4, s[32:35], s67 offen lds
    v_mfma_f32_32x32x16_bf16 v[176:191], v[244:247], v[52:55], v[176:191]
    ds_read_b64_tr_b16 v[232:233], v14 offset:2048
    ds_read_b64_tr_b16 v[234:235], v14 offset:2560
    s_lshl_b32 s86, s82, 4
    s_add_u32 s86, s86, s71
    s_lshl_b32 s86, s86, 1
    s_add_u32 s86, s86, s63
    s_lshl_b32 s86, s86, 10
    s_add_u32 s101, s86, 0xd00000
    s_lshl_b32 s83, s83, 5
    s_add_u32 s83, s83, 0xf00000
    s_lshl_b32 s84, s84, 5
    s_add_u32 s84, s84, 0xf00000
    s_lshl_b32 s85, s85, 5
    s_add_u32 s85, s85, 0xf00000
    s_cmp_lg_u32 s62, 0
    s_cselect_b32 s3, 0x7ffffff0, 0
    v_mfma_f32_16x16x32_bf16 v[196:199], v[28:31], v[240:243], v[196:199]
    v_lshlrev_b32 v208, 16, v50
    v_and_b32 v209, 0xffff0000, v50
    v_lshlrev_b32 v210, 16, v51
    v_and_b32 v211, 0xffff0000, v51
    v_add_f32 v204, v204, v208
    v_add_f32 v205, v205, v209
    v_fmac_f32 v206, v208, v208
    v_fmac_f32 v207, v209, v209
    v_add_f32 v204, v204, v210
    v_add_f32 v205, v205, v211
    v_fmac_f32 v206, v210, v210
    v_fmac_f32 v207, v211, v211
    v_add_u32 v15, 0x10000, v15
    s_waitcnt lgkmcnt(0)
    v_mfma_f32_32x32x16_bf16 v[144:159], v[224:227], v[56:59], v[144:159]
    s_setprio 0
    ds_read_b128 v[60:63], v19 offset:40960
    ds_read_b64_tr_b16 v[236:237], v23 offset:57344
    ds_read_b64_tr_b16 v[238:239], v23 offset:57856
    s_add_u32 m0, s65, 155648
    s_add_u32 s67, s67, 114688
    buffer_load_dwordx4 v4, s[32:35], s67 offen lds
    v_mfma_f32_32x32x16_bf16 v[160:175], v[228:231], v[56:59], v[160:175]
    ds_read_b64_tr_b16 v[240:241], v15
    ds_read_b64_tr_b16 v[242:243], v15 offset:512
    v_mfma_f32_32x32x16_bf16 v[176:191], v[232:235], v[56:59], v[176:191]
    ds_read_b64_tr_b16 v[244:245], v15 offset:2048
    ds_read_b64_tr_b16 v[246:247], v15 offset:2560
    v_mfma_f32_16x16x32_bf16 v[200:203], v[28:31], v[232:235], v[200:203]
    v_lshlrev_b32 v208, 16, v56
    v_and_b32 v209, 0xffff0000, v56
    v_lshlrev_b32 v210, 16, v57
    v_and_b32 v211, 0xffff0000, v57
    v_add_f32 v204, v204, v208
    v_add_f32 v205, v205, v209
    v_fmac_f32 v206, v208, v208
    v_fmac_f32 v207, v209, v209
    v_add_f32 v204, v204, v210
    v_add_f32 v205, v205, v211
    v_fmac_f32 v206, v210, v210
    v_fmac_f32 v207, v211, v211
    v_add_u32 v16, 0x14000, v16
    v_add_u32 v20, 0x18000, v20
    s_waitcnt vmcnt(5)
    s_waitcnt lgkmcnt(0)
    s_barrier
    v_mfma_f32_32x32x16_bf16 v[144:159], v[236:239], v[60:63], v[144:159]
    s_setprio 3
    ds_read_b128 v[64:67], v16
    ds_read_b64_tr_b16 v[224:225], v20
    ds_read_b64_tr_b16 v[226:227], v20 offset:512
    s_add_u32 m0, s65, 0
    s_add_u32 s67, s67, 114688
    buffer_load_dwordx4 v2, s[24:27], s91 offen lds
    v_mfma_f32_32x32x16_bf16 v[160:175], v[240:243], v[60:63], v[160:175]
    ds_read_b64_tr_b16 v[228:229], v12 offset:40960
    ds_read_b64_tr_b16 v[230:231], v12 offset:41472
    s_add_u32 m0, s65, 8192
    s_add_u32 s91, s91, 57344
    buffer_load_dwordx4 v2, s[24:27], s91 offen lds
    v_mfma_f32_32x32x16_bf16 v[176:191], v[244:247], v[60:63], v[176:191]
    ds_read_b64_tr_b16 v[232:233], v12 offset:43008
    ds_read_b64_tr_b16 v[234:235], v12 offset:43520
    v_lshlrev_b32 v208, 16, v58
    v_and_b32 v209, 0xffff0000, v58
    v_lshlrev_b32 v210, 16, v59
    v_and_b32 v211, 0xffff0000, v59
    v_add_f32 v204, v204, v208
    v_add_f32 v205, v205, v209
    v_fmac_f32 v206, v208, v208
    v_fmac_f32 v207, v209, v209
    v_add_f32 v204, v204, v210
    v_add_f32 v205, v205, v211
    v_fmac_f32 v206, v210, v210
    v_fmac_f32 v207, v211, v211
    v_add_u32 v17, 0x14000, v17
    v_add_u32 v21, 0x18000, v21
    s_waitcnt lgkmcnt(0)
    v_mfma_f32_32x32x16_bf16 v[144:159], v[224:227], v[64:67], v[144:159]
    s_setprio 2
    ds_read_b128 v[68:71], v17
    ds_read_b64_tr_b16 v[236:237], v21
    ds_read_b64_tr_b16 v[238:239], v21 offset:512
    s_add_u32 m0, s65, 16384
    s_sub_u32 s91, s91, 57216
    buffer_load_dwordx4 v3, s[28:31], s66 offen lds
    v_mfma_f32_32x32x16_bf16 v[160:175], v[228:231], v[64:67], v[160:175]
    ds_read_b64_tr_b16 v[240:241], v13 offset:40960
    ds_read_b64_tr_b16 v[242:243], v13 offset:41472
    s_sub_u32 s86, s2, 64
    s_cmp_lt_u32 s86, 64
    s_cbranch_scc0 L_Z5
    s_lshl_b32 s86, s86, 2
    s_lshl_b32 s87, s63, 1
    s_add_u32 s86, s86, s87
    s_add_u32 s86, s86, s79
    s_mul_i32 s86, s86, 7168
    s_add_u32 s86, s86, 1536
    v_and_b32 v217, 15, v0
    v_lshlrev_b32 v217, 7, v217
    v_bfe_u32 v218, v0, 4, 1
    v_mul_u32_u24 v218, 3584, v218
    v_add_u32 v217, v217, v218
    buffer_load_dword v216, v217, s[36:39], s86 offen
L_Z5:
    v_mfma_f32_32x32x16_bf16 v[176:191], v[232:235], v[64:67], v[176:191]
    ds_read_b64_tr_b16 v[244:245], v13 offset:43008
    ds_read_b64_tr_b16 v[246:247], v13 offset:43520
    v_mfma_f32_16x16x32_bf16 v[192:195], v[28:31], v[224:227], v[192:195]
    v_lshlrev_b32 v208, 16, v64
    v_and_b32 v209, 0xffff0000, v64
    v_lshlrev_b32 v210, 16, v65
    v_and_b32 v211, 0xffff0000, v65
    v_add_f32 v204, v204, v208
    v_add_f32 v205, v205, v209
    v_fmac_f32 v206, v208, v208
    v_fmac_f32 v207, v209, v209
    v_add_f32 v204, v204, v210
    v_add_f32 v205, v205, v211
    v_fmac_f32 v206, v210, v210
    v_fmac_f32 v207, v211, v211
    v_add_u32 v18, 0x14000, v18
    v_add_u32 v22, 0x18000, v22
    s_waitcnt lgkmcnt(0)
    v_mfma_f32_32x32x16_bf16 v[144:159], v[236:239], v[68:71], v[144:159]
    s_setprio 1
    ds_read_b128 v[72:75], v18
    ds_read_b64_tr_b16 v[224:225], v22
    ds_read_b64_tr_b16 v[226:227], v22 offset:512
    s_add_u32 m0, s65, 24576
    s_add_u32 s66, s66, 172032
    buffer_load_dwordx4 v4, s[32:35], s67 offen lds
    v_mfma_f32_32x32x16_bf16 v[160:175], v[240:243], v[68:71], v[160:175]
    ds_read_b64_tr_b16 v[228:229], v14 offset:40960
    ds_read_b64_tr_b16 v[230:231], v14 offset:41472
    s_add_u32 m0, s65, 32768
    s_add_u32 s67, s67, 114688
    buffer_load_dwordx4 v4, s[32:35], s67 offen lds
    v_mfma_f32_32x32x16_bf16 v[176:191], v[244:247], v[68:71], v[176:191]
    ds_read_b64_tr_b16 v[232:233], v14 offset:43008
    ds_read_b64_tr_b16 v[234:235], v14 offset:43520
    v_mfma_f32_16x16x32_bf16 v[196:199], v[28:31], v[240:243], v[196:199]
    v_lshlrev_b32 v208, 16, v66
    v_and_b32 v209, 0xffff0000, v66
    v_lshlrev_b32 v210, 16, v67
    v_and_b32 v211, 0xffff0000, v67
    v_add_f32 v204, v204, v208
    v_add_f32 v205, v205, v209
    v_fmac_f32 v206, v208, v208
    v_fmac_f32 v207, v209, v209
    v_add_f32 v204, v204, v210
    v_add_f32 v205, v205, v211
    v_fmac_f32 v206, v210, v210
    v_fmac_f32 v207, v211, v211
    v_add_u32 v19, 0x14000, v19
    v_add_u32 v23, 0x18000, v23
    s_waitcnt lgkmcnt(0)
    v_mfma_f32_32x32x16_bf16 v[144:159], v[224:227], v[72:75], v[144:159]
    s_setprio 0
    ds_read_b128 v[76:79], v19
    ds_read_b64_tr_b16 v[236:237], v23
    ds_read_b64_tr_b16 v[238:239], v23 offset:512
    s_add_u32 m0, s65, 40960
    s_add_u32 s67, s67, 114688
    buffer_load_dwordx4 v2, s[24:27], s91 offen lds
    v_mfma_f32_32x32x16_bf16 v[160:175], v[228:231], v[72:75], v[160:175]
    ds_read_b64_tr_b16 v[240:241], v15 offset:40960
    ds_read_b64_tr_b16 v[242:243], v15 offset:41472
    v_mfma_f32_32x32x16_bf16 v[176:191], v[232:235], v[72:75], v[176:191]
    ds_read_b64_tr_b16 v[244:245], v15 offset:43008
    ds_read_b64_tr_b16 v[246:247], v15 offset:43520
    v_mfma_f32_16x16x32_bf16 v[200:203], v[28:31], v[232:235], v[200:203]
    v_lshlrev_b32 v208, 16, v72
    v_and_b32 v209, 0xffff0000, v72
    v_lshlrev_b32 v210, 16, v73
    v_and_b32 v211, 0xffff0000, v73
    v_add_f32 v204, v204, v208
    v_add_f32 v205, v205, v209
    v_fmac_f32 v206, v208, v208
    v_fmac_f32 v207, v209, v209
    v_add_f32 v204, v204, v210
    v_add_f32 v205, v205, v211
    v_fmac_f32 v206, v210, v210
    v_fmac_f32 v207, v211, v211
    v_add_u32 v12, 0x14000, v12
    s_waitcnt vmcnt(6)
    s_waitcnt lgkmcnt(0)
    s_barrier
    s_or_b32 s86, s9, s3
    s_cmp_lt_u32 s86, 256
    s_cbranch_scc0 L_G6
    buffer_store_dword v248, v7, s[56:59], s9 offen sc1
L_G6:
    v_mfma_f32_32x32x16_bf16 v[144:159], v[236:239], v[76:79], v[144:159]
    s_setprio 3
    ds_read_b128 v[80:83], v16 offset:40960
    ds_read_b64_tr_b16 v[224:225], v20 offset:40960
    ds_read_b64_tr_b16 v[226:227], v20 offset:41472
    s_add_u32 m0, s65, 49152
    s_add_u32 s91, s91, 57344
    buffer_load_dwordx4 v2, s[24:27], s91 offen lds
    v_mfma_f32_32x32x16_bf16 v[160:175], v[240:243], v[76:79], v[160:175]
    ds_read_b64_tr_b16 v[228:229], v12
    ds_read_b64_tr_b16 v[230:231], v12 offset:512
    s_add_u32 m0, s65, 57344
    s_sub_u32 s91, s91, 57216
    buffer_load_dwordx4 v3, s[28:31], s66 offen lds
    v_mfma_f32_32x32x16_bf16 v[176:191], v[244:247], v[76:79], v[176:191]
    ds_read_b64_tr_b16 v[232:233], v12 offset:2048
    ds_read_b64_tr_b16 v[234:235], v12 offset:2560
    v_lshlrev_b32 v208, 16, v74
    v_and_b32 v209, 0xffff0000, v74
    v_lshlrev_b32 v210, 16, v75
    v_and_b32 v211, 0xffff0000, v75
    v_add_f32 v204, v204, v208
    v_add_f32 v205, v205, v209
    v_fmac_f32 v206, v208, v208
    v_fmac_f32 v207, v209, v209
    v_add_f32 v204, v204, v210
    v_add_f32 v205, v205, v211
    v_fmac_f32 v206, v210, v210
    v_fmac_f32 v207, v211, v211
    v_add_u32 v13, 0x14000, v13
    s_waitcnt lgkmcnt(0)
    v_mfma_f32_32x32x16_bf16 v[144:159], v[224:227], v[80:83], v[144:159]
    s_setprio 2
    ds_read_b128 v[84:87], v17 offset:40960
    ds_read_b64_tr_b16 v[236:237], v21 offset:40960
    ds_read_b64_tr_b16 v[238:239], v21 offset:41472
    s_add_u32 m0, s65, 65536
    s_add_u32 s66, s66, 172032
    buffer_load_dwordx4 v4, s[32:35], s67 offen lds
    v_mfma_f32_32x32x16_bf16 v[160:175], v[228:231], v[80:83], v[160:175]
    ds_read_b64_tr_b16 v[240:241], v13
    ds_read_b64_tr_b16 v[242:243], v13 offset:512
    v_mfma_f32_32x32x16_bf16 v[176:191], v[232:235], v[80:83], v[176:191]
    ds_read_b64_tr_b16 v[244:245], v13 offset:2048
    ds_read_b64_tr_b16 v[246:247], v13 offset:2560
    v_mfma_f32_16x16x32_bf16 v[192:195], v[28:31], v[224:227], v[192:195]
    v_lshlrev_b32 v208, 16, v80
    v_and_b32 v209, 0xffff0000, v80
    v_lshlrev_b32 v210, 16, v81
    v_and_b32 v211, 0xffff0000, v81
    v_add_f32 v204, v204, v208
    v_add_f32 v205, v205, v209
    v_fmac_f32 v206, v208, v208
    v_fmac_f32 v207, v209, v209
    v_add_f32 v204, v204, v210
    v_add_f32 v205, v205, v211
    v_fmac_f32 v206, v210, v210
    v_fmac_f32 v207, v211, v211
    v_add_u32 v14, 0x14000, v14
    s_waitcnt lgkmcnt(0)
    v_mfma_f32_32x32x16_bf16 v[144:159], v[236:239], v[84:87], v[144:159]
    s_setprio 1
    ds_read_b128 v[88:91], v18 offset:40960
    ds_read_b64_tr_b16 v[224:225], v22 offset:40960
    ds_read_b64_tr_b16 v[226:227], v22 offset:41472
    s_add_u32 m0, s65, 73728
    s_add_u32 s67, s67, 114688
    buffer_load_dwordx4 v4, s[32:35], s67 offen lds
    v_mfma_f32_32x32x16_bf16 v[160:175], v[240:243], v[84:87], v[160:175]
    ds_read_b64_tr_b16 v[228:229], v14
    ds_read_b64_tr_b16 v[230:231], v14 offset:512
    s_add_u32 m0, s65, 81920
    s_add_u32 s67, s67, 114688
    buffer_load_dwordx4 v2, s[24:27], s91 offen lds
    v_mfma_f32_32x32x16_bf16 v[176:191], v[244:247], v[84:87], v[176:191]
    ds_read_b64_tr_b16 v[232:233], v14 offset:2048
    ds_read_b64_tr_b16 v[234:235], v14 offset:2560
    v_mfma_f32_16x16x32_bf16 v[196:199], v[28:31], v[240:243], v[196:199]
    v_lshlrev_b32 v208, 16, v82
    v_and_b32 v209, 0xffff0000, v82
    v_lshlrev_b32 v210, 16, v83
    v_and_b32 v211, 0xffff0000, v83
    v_add_f32 v204, v204, v208
    v_add_f32 v205, v205, v209
    v_fmac_f32 v206, v208, v208
    v_fmac_f32 v207, v209, v209
    v_add_f32 v204, v204, v210
    v_add_f32 v205, v205, v211
    v_fmac_f32 v206, v210, v210
    v_fmac_f32 v207, v211, v211
    v_add_u32 v15, 0x14000, v15
    s_waitcnt lgkmcnt(0)
    v_mfma_f32_32x32x16_bf16 v[144:159], v[224:227], v[88:91], v[144:159]
    s_setprio 0
    ds_read_b128 v[92:95], v19 offset:40960
    ds_read_b64_tr_b16 v[236:237], v23 offset:40960
    ds_read_b64_tr_b16 v[238:239], v23 offset:41472
    s_add_u32 m0, s65, 90112
    s_add_u32 s91, s91, 57344
    buffer_load_dwordx4 v2, s[24:27], s91 offen lds
    v_mfma_f32_32x32x16_bf16 v[160:175], v[228:231], v[88:91], v[160:175]
    ds_read_b64_tr_b16 v[240:241], v15
    ds_read_b64_tr_b16 v[242:243], v15 offset:512
    v_mfma_f32_32x32x16_bf16 v[176:191], v[232:235], v[88:91], v[176:191]
    ds_read_b64_tr_b16 v[244:245], v15 offset:2048
    ds_read_b64_tr_b16 v[246:247], v15 offset:2560
    v_mfma_f32_16x16x32_bf16 v[200:203], v[28:31], v[232:235], v[200:203]
    v_lshlrev_b32 v208, 16, v88
    v_and_b32 v209, 0xffff0000, v88
    v_lshlrev_b32 v210, 16, v89
    v_and_b32 v211, 0xffff0000, v89
    v_add_f32 v204, v204, v208
    v_add_f32 v205, v205, v209
    v_fmac_f32 v206, v208, v208
    v_fmac_f32 v207, v209, v209
    v_add_f32 v204, v204, v210
    v_add_f32 v205, v205, v211
    v_fmac_f32 v206, v210, v210
    v_fmac_f32 v207, v211, v211
    v_add_u32 v16, 0xfffec000, v16
    v_add_u32 v20, 0xfffec000, v20
    v_add_u32 v12, 0xfffe2000, v12
    s_waitcnt vmcnt(7)
    s_waitcnt lgkmcnt(0)
    s_barrier
    v_mfma_f32_32x32x16_bf16 v[144:159], v[236:239], v[92:95], v[144:159]
    s_setprio 3
    ds_read_b128 v[96:99], v16
    ds_read_b64_tr_b16 v[224:225], v20
    ds_read_b64_tr_b16 v[226:227], v20 offset:512
    s_add_u32 m0, s65, 98304
    s_sub_u32 s91, s91, 57216
    buffer_load_dwordx4 v3, s[28:31], s66 offen lds
    v_mfma_f32_32x32x16_bf16 v[160:175], v[240:243], v[92:95], v[160:175]
    ds_read_b64_tr_b16 v[228:229], v12
    ds_read_b64_tr_b16 v[230:231], v12 offset:512
    s_add_u32 m0, s65, 106496
    s_add_u32 s66, s66, 172032
    buffer_load_dwordx4 v4, s[32:35], s67 offen lds
    v_mfma_f32_32x32x16_bf16 v[176:191], v[244:247], v[92:95], v[176:191]
    ds_read_b64_tr_b16 v[232:233], v12 offset:2048
    ds_read_b64_tr_b16 v[234:235], v12 offset:2560
    v_lshlrev_b32 v208, 16, v90
    v_and_b32 v209, 0xffff0000, v90
    v_lshlrev_b32 v210, 16, v91
    v_and_b32 v211, 0xffff0000, v91
    v_add_f32 v204, v204, v208
    v_add_f32 v205, v205, v209
    v_fmac_f32 v206, v208, v208
    v_fmac_f32 v207, v209, v209
    v_add_f32 v204, v204, v210
    v_add_f32 v205, v205, v211
    v_fmac_f32 v206, v210, v210
    v_fmac_f32 v207, v211, v211
    v_add_u32 v17, 0xfffec000, v17
    v_add_u32 v21, 0xfffec000, v21
    v_add_u32 v13, 0xfffe2000, v13
    s_waitcnt lgkmcnt(0)
    v_mfma_f32_32x32x16_bf16 v[144:159], v[224:227], v[96:99], v[144:159]
    s_setprio 2
    ds_read_b128 v[100:103], v17
    ds_read_b64_tr_b16 v[236:237], v21
    ds_read_b64_tr_b16 v[238:239], v21 offset:512
    s_add_u32 m0, s65, 114688
    s_add_u32 s67, s67, 114688
    buffer_load_dwordx4 v4, s[32:35], s67 offen lds
    v_mfma_f32_32x32x16_bf16 v[160:175], v[228:231], v[96:99], v[160:175]
    ds_read_b64_tr_b16 v[240:241], v13
    ds_read_b64_tr_b16 v[242:243], v13 offset:512
    s_sub_u32 s86, s2, 0
    s_cmp_lt_u32 s86, 64
    s_cbranch_scc0 L_Z7
    s_lshl_b32 s86, s86, 3
    s_add_u32 s86, s86, s62
    s_mul_i32 s87, s86, 3200
    v_min_u32 v217, 24, v0
    v_lshlrev_b32 v217, 7, v217
    buffer_load_dword v216, v217, s[44:47], s87 offen
    s_mul_i32 s87, s86, 896
    v_min_u32 v217, 0x300, v217
    buffer_load_dword v216, v217, s[48:51], s87 offen
L_Z7:
    v_mfma_f32_32x32x16_bf16 v[176:191], v[232:235], v[96:99], v[176:191]
    ds_read_b64_tr_b16 v[244:245], v13 offset:2048
    ds_read_b64_tr_b16 v[246:247], v13 offset:2560
    v_mfma_f32_16x16x32_bf16 v[192:195], v[28:31], v[224:227], v[192:195]
    v_lshlrev_b32 v208, 16, v96
    v_and_b32 v209, 0xffff0000, v96
    v_lshlrev_b32 v210, 16, v97
    v_and_b32 v211, 0xffff0000, v97
    v_add_f32 v204, v204, v208
    v_add_f32 v205, v205, v209
    v_fmac_f32 v206, v208, v208
    v_fmac_f32 v207, v209, v209
    v_add_f32 v204, v204, v210
    v_add_f32 v205, v205, v211
    v_fmac_f32 v206, v210, v210
    v_fmac_f32 v207, v211, v211
    v_add_u32 v18, 0xfffec000, v18
    v_add_u32 v22, 0xfffec000, v22
    v_add_u32 v14, 0xfffe2000, v14
    s_waitcnt lgkmcnt(0)
    v_mfma_f32_32x32x16_bf16 v[144:159], v[236:239], v[100:103], v[144:159]
    s_setprio 1
    ds_read_b128 v[104:107], v18
    ds_read_b64_tr_b16 v[224:225], v22
    ds_read_b64_tr_b16 v[226:227], v22 offset:512
    s_add_u32 m0, s65, 122880
    s_add_u32 s67, s67, 114688
    buffer_load_dwordx4 v251, s[36:39], s69 offen lds
    v_mfma_f32_32x32x16_bf16 v[160:175], v[240:243], v[100:103], v[160:175]
    ds_read_b64_tr_b16 v[228:229], v14
    ds_read_b64_tr_b16 v[230:231], v14 offset:512
    s_add_u32 m0, s65, 131072
    s_add_u32 s69, s69, 114688
    buffer_load_dwordx4 v251, s[36:39], s69 offen lds
    v_mfma_f32_32x32x16_bf16 v[176:191], v[244:247], v[100:103], v[176:191]
    ds_read_b64_tr_b16 v[232:233], v14 offset:2048
    ds_read_b64_tr_b16 v[234:235], v14 offset:2560
    v_mfma_f32_16x16x32_bf16 v[196:199], v[28:31], v[240:243], v[196:199]
    v_lshlrev_b32 v208, 16, v98
    v_and_b32 v209, 0xffff0000, v98
    v_lshlrev_b32 v210, 16, v99
    v_and_b32 v211, 0xffff0000, v99
    v_add_f32 v204, v204, v208
    v_add_f32 v205, v205, v209
    v_fmac_f32 v206, v208, v208
    v_fmac_f32 v207, v209, v209
    v_add_f32 v204, v204, v210
    v_add_f32 v205, v205, v211
    v_fmac_f32 v206, v210, v210
    v_fmac_f32 v207, v211, v211
    v_add_u32 v19, 0xfffec000, v19
    v_add_u32 v23, 0xfffec000, v23
    v_add_u32 v15, 0xfffe2000, v15
    s_waitcnt lgkmcnt(0)
    v_mfma_f32_32x32x16_bf16 v[144:159], v[224:227], v[104:107], v[144:159]
    s_setprio 0
    ds_read_b128 v[108:111], v19
    ds_read_b64_tr_b16 v[236:237], v23
    ds_read_b64_tr_b16 v[238:239], v23 offset:512
    s_add_u32 m0, s65, 139264
    s_add_u32 s69, s69, 114688
    buffer_load_dwordx4 v251, s[36:39], s69 offen lds
    v_mfma_f32_32x32x16_bf16 v[160:175], v[228:231], v[104:107], v[160:175]
    ds_read_b64_tr_b16 v[240:241], v15
    ds_read_b64_tr_b16 v[242:243], v15 offset:512
    v_mfma_f32_32x32x16_bf16 v[176:191], v[232:235], v[104:107], v[176:191]
    ds_read_b64_tr_b16 v[244:245], v15 offset:2048
    ds_read_b64_tr_b16 v[246:247], v15 offset:2560
    v_mfma_f32_16x16x32_bf16 v[200:203], v[28:31], v[232:235], v[200:203]
    v_lshlrev_b32 v208, 16, v104
    v_and_b32 v209, 0xffff0000, v104
    v_lshlrev_b32 v210, 16, v105
    v_and_b32 v211, 0xffff0000, v105
    v_add_f32 v204, v204, v208
    v_add_f32 v205, v205, v209
    v_fmac_f32 v206, v208, v208
    v_fmac_f32 v207, v209, v209
    v_add_f32 v204, v204, v210
    v_add_f32 v205, v205, v211
    v_fmac_f32 v206, v210, v210
    v_fmac_f32 v207, v211, v211
    s_waitcnt vmcnt(8)
    s_waitcnt lgkmcnt(0)
    s_barrier
    v_and_b32 v254, 15, v0
    v_mul_u32_u24 v254, 16, v254
    v_or_b32 v254, s3, v254
    s_cmp_eq_u32 s62, 0
    s_cbranch_scc0 L_G8
    buffer_load_dword v253, v254, s[56:59], 0 offen sc1
L_G8:
    v_mfma_f32_32x32x16_bf16 v[144:159], v[236:239], v[108:111], v[144:159]
    s_setprio 3
    ds_read_b128 v[112:115], v16 offset:40960
    ds_read_b64_tr_b16 v[224:225], v20 offset:40960
    ds_read_b64_tr_b16 v[226:227], v20 offset:41472
    s_add_u32 m0, s65, 147456
    s_add_u32 s69, s69, 114688
    buffer_load_dwordx4 v251, s[36:39], s69 offen lds
    v_mfma_f32_32x32x16_bf16 v[160:175], v[240:243], v[108:111], v[160:175]
    ds_read_b64_tr_b16 v[228:229], v12 offset:40960
    ds_read_b64_tr_b16 v[230:231], v12 offset:41472
    s_add_u32 m0, s65, 0
    s_add_u32 s69, s69, 114688
    buffer_load_dwordx4 v251, s[36:39], s69 offen lds
    v_mfma_f32_32x32x16_bf16 v[176:191], v[244:247], v[108:111], v[176:191]
    ds_read_b64_tr_b16 v[232:233], v12 offset:43008
    ds_read_b64_tr_b16 v[234:235], v12 offset:43520
    v_lshlrev_b32 v208, 16, v106
    v_and_b32 v209, 0xffff0000, v106
    v_lshlrev_b32 v210, 16, v107
    v_and_b32 v211, 0xffff0000, v107
    v_add_f32 v204, v204, v208
    v_add_f32 v205, v205, v209
    v_fmac_f32 v206, v208, v208
    v_fmac_f32 v207, v209, v209
    v_add_f32 v204, v204, v210
    v_add_f32 v205, v205, v211
    v_fmac_f32 v206, v210, v210
    v_fmac_f32 v207, v211, v211
    s_waitcnt lgkmcnt(0)
    v_mfma_f32_32x32x16_bf16 v[144:159], v[224:227], v[112:115], v[144:159]
    s_setprio 2
    ds_read_b128 v[116:119], v17 offset:40960
    ds_read_b64_tr_b16 v[236:237], v21 offset:40960
    ds_read_b64_tr_b16 v[238:239], v21 offset:41472
    s_add_u32 m0, s65, 8192
    s_add_u32 s69, s69, 114688
    buffer_load_dwordx4 v251, s[36:39], s69 offen lds
    v_mfma_f32_32x32x16_bf16 v[160:175], v[228:231], v[112:115], v[160:175]
    ds_read_b64_tr_b16 v[240:241], v13 offset:40960
    ds_read_b64_tr_b16 v[242:243], v13 offset:41472
    v_mfma_f32_32x32x16_bf16 v[176:191], v[232:235], v[112:115], v[176:191]
    ds_read_b64_tr_b16 v[244:245], v13 offset:43008
    ds_read_b64_tr_b16 v[246:247], v13 offset:43520
    v_mfma_f32_16x16x32_bf16 v[192:195], v[28:31], v[224:227], v[192:195]
    v_lshlrev_b32 v208, 16, v112
    v_and_b32 v209, 0xffff0000, v112
    v_lshlrev_b32 v210, 16, v113
    v_and_b32 v211, 0xffff0000, v113
    v_add_f32 v204, v204, v208
    v_add_f32 v205, v205, v209
    v_fmac_f32 v206, v208, v208
    v_fmac_f32 v207, v209, v209
    v_add_f32 v204, v204, v210
    v_add_f32 v205, v205, v211
    v_fmac_f32 v206, v210, v210
    v_fmac_f32 v207, v211, v211
    s_waitcnt lgkmcnt(0)
    v_mfma_f32_32x32x16_bf16 v[144:159], v[236:239], v[116:119], v[144:159]
    s_setprio 1
    ds_read_b128 v[120:123], v18 offset:40960
    ds_read_b64_tr_b16 v[224:225], v22 offset:40960
    ds_read_b64_tr_b16 v[226:227], v22 offset:41472
    s_add_u32 m0, s65, 16384
    s_add_u32 s69, s69, 114688
    buffer_load_dwordx4 v251, s[36:39], s69 offen lds
    v_mfma_f32_32x32x16_bf16 v[160:175], v[240:243], v[116:119], v[160:175]
    ds_read_b64_tr_b16 v[228:229], v14 offset:40960
    ds_read_b64_tr_b16 v[230:231], v14 offset:41472
    s_add_u32 m0, s65, 24576
    s_add_u32 s69, s69, 114688
    buffer_load_dwordx4 v251, s[36:39], s69 offen lds
    v_mfma_f32_32x32x16_bf16 v[176:191], v[244:247], v[116:119], v[176:191]
    ds_read_b64_tr_b16 v[232:233], v14 offset:43008
    ds_read_b64_tr_b16 v[234:235], v14 offset:43520
    v_mfma_f32_16x16x32_bf16 v[196:199], v[28:31], v[240:243], v[196:199]
    v_lshlrev_b32 v208, 16, v114
    v_and_b32 v209, 0xffff0000, v114
    v_lshlrev_b32 v210, 16, v115
    v_and_b32 v211, 0xffff0000, v115
    v_add_f32 v204, v204, v208
    v_add_f32 v205, v205, v209
    v_fmac_f32 v206, v208, v208
    v_fmac_f32 v207, v209, v209
    v_add_f32 v204, v204, v210
    v_add_f32 v205, v205, v211
    v_fmac_f32 v206, v210, v210
    v_fmac_f32 v207, v211, v211
    s_waitcnt lgkmcnt(0)
    v_mfma_f32_32x32x16_bf16 v[144:159], v[224:227], v[120:123], v[144:159]
    s_setprio 0
    ds_read_b128 v[124:127], v19 offset:40960
    ds_read_b64_tr_b16 v[236:237], v23 offset:40960
    ds_read_b64_tr_b16 v[238:239], v23 offset:41472
    s_add_u32 m0, s65, 32768
    s_add_u32 s69, s69, 114688
    buffer_load_dwordx4 v6, s[44:47], s74 offen lds
    v_mfma_f32_32x32x16_bf16 v[160:175], v[228:231], v[120:123], v[160:175]
    ds_read_b64_tr_b16 v[240:241], v15 offset:40960
    ds_read_b64_tr_b16 v[242:243], v15 offset:41472
    v_mfma_f32_32x32x16_bf16 v[176:191], v[232:235], v[120:123], v[176:191]
    ds_read_b64_tr_b16 v[244:245], v15 offset:43008
    ds_read_b64_tr_b16 v[246:247], v15 offset:43520
    v_mfma_f32_16x16x32_bf16 v[200:203], v[28:31], v[232:235], v[200:203]
    v_lshlrev_b32 v208, 16, v120
    v_and_b32 v209, 0xffff0000, v120
    v_lshlrev_b32 v210, 16, v121
    v_and_b32 v211, 0xffff0000, v121
    v_add_f32 v204, v204, v208
    v_add_f32 v205, v205, v209
    v_fmac_f32 v206, v208, v208
    v_fmac_f32 v207, v209, v209
    v_add_f32 v204, v204, v210
    v_add_f32 v205, v205, v211
    v_fmac_f32 v206, v210, v210
    v_fmac_f32 v207, v211, v211
    v_add_u32 v16, 0x14000, v16
    v_add_u32 v20, 0x14000, v20
    v_add_u32 v12, 0x14000, v12
    s_waitcnt vmcnt(9)
    s_cmp_lg_u32 s62, 0
    s_cbranch_scc1 L_OK9
    s_waitcnt vmcnt(6)
    s_mov_b32 s90, 100000
L_SP9:
    v_and_b32 v253, 0xff, v253
    v_cmp_ne_u32 vcc, 1, v253
    s_nop 1
    s_cbranch_vccz L_OK9
    s_sleep 4
    buffer_load_dword v253, v254, s[56:59], 0 offen sc1
    s_sub_u32 s90, s90, 1
    s_waitcnt vmcnt(0)
    s_cbranch_scc0 L_SP9
L_OK9:
    s_waitcnt lgkmcnt(0)
    s_barrier
    v_mfma_f32_32x32x16_bf16 v[144:159], v[236:239], v[124:127], v[144:159]
    s_setprio 3
    ds_read_b128 v[128:131], v16
    ds_read_b64_tr_b16 v[224:225], v20
    ds_read_b64_tr_b16 v[226:227], v20 offset:512
    s_add_u32 m0, s65, 40960
    s_add_u32 s74, s74, 14336
    buffer_load_dwordx4 v251, s[36:39], s69 offen lds
    v_mfma_f32_32x32x16_bf16 v[160:175], v[240:243], v[124:127], v[160:175]
    ds_read_b64_tr_b16 v[228:229], v12
    ds_read_b64_tr_b16 v[230:231], v12 offset:512
    s_add_u32 m0, s65, 49152
    s_add_u32 s69, s69, 114688
    buffer_load_dwordx4 v251, s[36:39], s69 offen lds
    v_mfma_f32_32x32x16_bf16 v[176:191], v[244:247], v[124:127], v[176:191]
    ds_read_b64_tr_b16 v[232:233], v12 offset:2048
    ds_read_b64_tr_b16 v[234:235], v12 offset:2560
    v_lshlrev_b32 v208, 16, v122
    v_and_b32 v209, 0xffff0000, v122
    v_lshlrev_b32 v210, 16, v123
    v_and_b32 v211, 0xffff0000, v123
    v_add_f32 v204, v204, v208
    v_add_f32 v205, v205, v209
    v_fmac_f32 v206, v208, v208
    v_fmac_f32 v207, v209, v209
    v_add_f32 v204, v204, v210
    v_add_f32 v205, v205, v211
    v_fmac_f32 v206, v210, v210
    v_fmac_f32 v207, v211, v211
    v_add_u32 v17, 0x14000, v17
    v_add_u32 v21, 0x14000, v21
    v_add_u32 v13, 0x14000, v13
    s_waitcnt lgkmcnt(0)
    v_mfma_f32_32x32x16_bf16 v[144:159], v[224:227], v[128:131], v[144:159]
    s_setprio 2
    ds_read_b128 v[132:135], v17
    ds_read_b64_tr_b16 v[236:237], v21
    ds_read_b64_tr_b16 v[238:239], v21 offset:512
    s_add_u32 m0, s65, 57344
    s_add_u32 s69, s69, 114688
    buffer_load_dwordx4 v251, s[36:39], s69 offen lds
    v_mfma_f32_32x32x16_bf16 v[160:175], v[228:231], v[128:131], v[160:175]
    ds_read_b64_tr_b16 v[240:241], v13
    ds_read_b64_tr_b16 v[242:243], v13 offset:512
    v_mfma_f32_32x32x16_bf16 v[176:191], v[232:235], v[128:131], v[176:191]
    ds_read_b64_tr_b16 v[244:245], v13 offset:2048
    ds_read_b64_tr_b16 v[246:247], v13 offset:2560
    v_mfma_f32_16x16x32_bf16 v[192:195], v[28:31], v[224:227], v[192:195]
    v_lshlrev_b32 v208, 16, v128
    v_and_b32 v209, 0xffff0000, v128
    v_lshlrev_b32 v210, 16, v129
    v_and_b32 v211, 0xffff0000, v129
    v_add_f32 v204, v204, v208
    v_add_f32 v205, v205, v209
    v_fmac_f32 v206, v208, v208
    v_fmac_f32 v207, v209, v209
    v_add_f32 v204, v204, v210
    v_add_f32 v205, v205, v211
    v_fmac_f32 v206, v210, v210
    v_fmac_f32 v207, v211, v211
    v_add_u32 v18, 0x14000, v18
    v_add_u32 v22, 0x14000, v22
    v_add_u32 v14, 0x14000, v14
    s_waitcnt lgkmcnt(0)
    v_mfma_f32_32x32x16_bf16 v[144:159], v[236:239], v[132:135], v[144:159]
    s_setprio 1
    ds_read_b128 v[136:139], v18
    ds_read_b64_tr_b16 v[224:225], v22
    ds_read_b64_tr_b16 v[226:227], v22 offset:512
    s_add_u32 m0, s65, 65536
    s_add_u32 s69, s69, 114688
    buffer_load_dwordx4 v251, s[36:39], s69 offen lds
    v_mfma_f32_32x32x16_bf16 v[160:175], v[240:243], v[132:135], v[160:175]
    ds_read_b64_tr_b16 v[228:229], v14
    ds_read_b64_tr_b16 v[230:231], v14 offset:512
    s_add_u32 m0, s65, 73728
    s_add_u32 s69, s69, 114688
    buffer_load_dwordx4 v6, s[44:47], s74 offen lds
    v_mfma_f32_32x32x16_bf16 v[176:191], v[244:247], v[132:135], v[176:191]
    ds_read_b64_tr_b16 v[232:233], v14 offset:2048
    ds_read_b64_tr_b16 v[234:235], v14 offset:2560
    v_mfma_f32_16x16x32_bf16 v[196:199], v[28:31], v[240:243], v[196:199]
    v_lshlrev_b32 v208, 16, v130
    v_and_b32 v209, 0xffff0000, v130
    v_lshlrev_b32 v210, 16, v131
    v_and_b32 v211, 0xffff0000, v131
    v_add_f32 v204, v204, v208
    v_add_f32 v205, v205, v209
    v_fmac_f32 v206, v208, v208
    v_fmac_f32 v207, v209, v209
    v_add_f32 v204, v204, v210
    v_add_f32 v205, v205, v211
    v_fmac_f32 v206, v210, v210
    v_fmac_f32 v207, v211, v211
    v_add_u32 v19, 0x14000, v19
    v_add_u32 v23, 0x14000, v23
    v_add_u32 v15, 0x14000, v15
    s_waitcnt lgkmcnt(0)
    v_mfma_f32_32x32x16_bf16 v[144:159], v[224:227], v[136:139], v[144:159]
    s_setprio 0
    ds_read_b128 v[140:143], v19
    ds_read_b64_tr_b16 v[236:237], v23
    ds_read_b64_tr_b16 v[238:239], v23 offset:512
    v_mfma_f32_32x32x16_bf16 v[160:175], v[228:231], v[136:139], v[160:175]
    ds_read_b64_tr_b16 v[240:241], v15
    ds_read_b64_tr_b16 v[242:243], v15 offset:512
    v_mfma_f32_32x32x16_bf16 v[176:191], v[232:235], v[136:139], v[176:191]
    ds_read_b64_tr_b16 v[244:245], v15 offset:2048
    ds_read_b64_tr_b16 v[246:247], v15 offset:2560
    v_mfma_f32_16x16x32_bf16 v[200:203], v[28:31], v[232:235], v[200:203]
    v_lshlrev_b32 v208, 16, v136
    v_and_b32 v209, 0xffff0000, v136
    v_lshlrev_b32 v210, 16, v137
    v_and_b32 v211, 0xffff0000, v137
    v_add_f32 v204, v204, v208
    v_add_f32 v205, v205, v209
    v_fmac_f32 v206, v208, v208
    v_fmac_f32 v207, v209, v209
    v_add_f32 v204, v204, v210
    v_add_f32 v205, v205, v211
    v_fmac_f32 v206, v210, v210
    v_fmac_f32 v207, v211, v211
    v_lshlrev_b32 v208, 16, v138
    v_and_b32 v209, 0xffff0000, v138
    v_lshlrev_b32 v210, 16, v139
    v_and_b32 v211, 0xffff0000, v139
    v_add_f32 v204, v204, v208
    v_add_f32 v205, v205, v209
    v_fmac_f32 v206, v208, v208
    v_fmac_f32 v207, v209, v209
    v_add_f32 v204, v204, v210
    v_add_f32 v205, v205, v211
    v_fmac_f32 v206, v210, v210
    v_fmac_f32 v207, v211, v211
    s_mul_i32 s86, s63, 1536
    v_add_u32 v249, s86, v249
    v_add_f32 v254, v204, v205
    v_add_f32 v255, v206, v207
    v_mov_b32 v204, v254
    v_mov_b32 v205, v255
    s_lshl_b32 s86, s63, 8
    v_add_u32 v206, s86, v250
    v_permlane32_swap_b32 v254, v204
    v_permlane32_swap_b32 v255, v205
    v_add_f32 v254, v254, v204
    v_add_f32 v255, v255, v205
    ds_write_b64 v206, v[254:255]
    ds_write_b32 v249, v192
    ds_write_b32 v249, v196 offset:512
    ds_write_b32 v249, v200 offset:1024
    v_and_b32 v249, 0xfffffff0, v249
    s_waitcnt vmcnt(8)
    s_waitcnt lgkmcnt(0)
    s_barrier
    v_mfma_f32_32x32x16_bf16 v[144:159], v[236:239], v[140:143], v[144:159]
    s_setprio 3
    ds_read_b64_tr_b16 v[224:225], v12 offset:16384
    ds_read_b64_tr_b16 v[226:227], v12 offset:16896
    s_add_u32 m0, s65, 81920
    s_add_u32 s74, s74, 14336
    buffer_load_dwordx4 v251, s[36:39], s69 offen lds
    ds_read_b64 v[204:205], v250
    ds_read_b64 v[206:207], v250 offset:256
    ds_read_b128 v[16:19], v249
    ds_read_b128 v[20:23], v249 offset:512
    ds_read_b128 v[24:27], v249 offset:1024
    v_mfma_f32_32x32x16_bf16 v[160:175], v[240:243], v[140:143], v[160:175]
    ds_read_b64_tr_b16 v[228:229], v12 offset:18432
    ds_read_b64_tr_b16 v[230:231], v12 offset:18944
    s_add_u32 m0, s65, 90112
    s_add_u32 s69, s69, 114688
    buffer_load_dwordx4 v251, s[36:39], s69 offen lds
    v_mfma_f32_32x32x16_bf16 v[176:191], v[244:247], v[140:143], v[176:191]
    s_waitcnt lgkmcnt(5)
    v_add_f32 v204, v204, v206
    v_add_f32 v205, v205, v207
    v_mul_f32 v204, 0x3b124925, v204
    v_mul_f32 v205, 0x3b124925, v205
    v_fma_f32 v205, -v204, v204, v205
    v_cvt_pk_bf16_f32 v2, -v204, -v204
    v_max_f32 v205, 0, v205
    v_cndmask_b32 v2, v2, 0, s[92:93]
    v_cvt_pk_bf16_f32 v205, 0, v205
    v_mov_b32 v3, 0
    v_add_f32 v205, 0x3727c5ac, v205
    v_mov_b32 v4, 0
    v_cvt_pk_bf16_f32 v205, 0, v205
    v_mov_b32 v5, 0
    v_sqrt_f32 v205, v205
    s_nop 0
    v_cvt_pk_bf16_f32 v254, 0, v205
    v_rcp_f32 v8, v254
    s_waitcnt lgkmcnt(4)
    v_add_f32 v16, v16, v17
    v_add_f32 v18, v18, v19
    s_waitcnt lgkmcnt(3)
    v_add_f32 v20, v20, v21
    v_add_f32 v22, v22, v23
    s_waitcnt lgkmcnt(2)
    v_add_f32 v24, v24, v25
    v_add_f32 v26, v26, v27
    v_add_f32 v16, v16, v18
    v_mov_b32 v19, 0
    v_add_f32 v20, v20, v22
    v_mov_b32 v23, 0
    v_add_f32 v24, v24, v26
    v_mov_b32 v27, 0
    v_and_b32 v17, 0xffff0000, v16
    v_mov_b32 v18, 0
    v_and_b32 v21, 0xffff0000, v20
    v_mov_b32 v22, 0
    v_and_b32 v25, 0xffff0000, v24
    v_mov_b32 v26, 0
    v_sub_f32 v16, v16, v17
    v_sub_f32 v20, v20, v21
    v_sub_f32 v24, v24, v25
    v_cvt_pk_bf16_f32 v16, v16, v17
    v_cvt_pk_bf16_f32 v20, v20, v21
    v_cvt_pk_bf16_f32 v24, v24, v25
    v_mov_b32 v17, 0
    v_mov_b32 v21, 0
    v_mov_b32 v25, 0
    s_waitcnt lgkmcnt(0)
    v_mfma_f32_32x32x16_bf16 v[144:159], v[16:19], v[2:5], v[144:159]
    v_mfma_f32_32x32x16_bf16 v[160:175], v[20:23], v[2:5], v[160:175]
    v_mfma_f32_32x32x16_bf16 v[176:191], v[24:27], v[2:5], v[176:191]
    v_mfma_f32_32x32x16_bf16 v[192:207], v[224:227], v[32:35], 0
    ds_read_b64_tr_b16 v[232:233], v13 offset:16384
    ds_read_b64_tr_b16 v[234:235], v13 offset:16896
    s_add_u32 m0, s65, 98304
    s_add_u32 s69, s69, 114688
    buffer_load_dwordx4 v6, s[44:47], s74 offen lds
    v_mfma_f32_32x32x16_bf16 v[208:223], v[228:231], v[32:35], 0
    ds_read_b64_tr_b16 v[236:237], v13 offset:18432
    ds_read_b64_tr_b16 v[238:239], v13 offset:18944
    v_mfma_f32_16x16x32_bf16 v[240:243], v[28:31], v[224:227], 0
    v_mul_f32 v26, v254, v254
    v_mul_f32 v24, 0xc0135761, v8
    v_mul_f32 v25, v8, v8
    v_mul_f32 v25, 0x3d372713, v25
    v_mul_f32 v25, v25, v24
    s_lshl_b32 s88, s100, 1
    s_add_u32 s88, s88, s63
    s_and_b32 s87, s88, 15
    s_lshl_b32 s87, s87, 6
    s_add_u32 s87, s87, s70
    s_lshl_b32 s80, s87, 11
    s_lshl_b32 s87, s87, 12
    s_add_u32 s87, s87, 0x200000
    s_cmp_ge_u32 s88, 16
    s_cselect_b32 s80, s87, s80
    s_cselect_b32 s87, 1.0, 0x3e8b97f6
    s_cselect_b32 s88, 1.0, 0
    s_cselect_b32 s4, -1, -2
    v_mul_f32 v254, s87, v8
    v_mov_b32 v255, s88
    v_cndmask_b32 v255, 0, v255, s[92:93]
    v_mul_f32 v144, v144, v254
    v_mul_f32 v145, v145, v254
    v_mul_f32 v146, v146, v254
    v_mul_f32 v147, v147, v254
    v_mul_f32 v148, v148, v254
    s_waitcnt lgkmcnt(0)
    v_mfma_f32_32x32x16_bf16 v[192:207], v[232:235], v[36:39], v[192:207]
    ds_read_b64_tr_b16 v[224:225], v14 offset:16384
    ds_read_b64_tr_b16 v[226:227], v14 offset:16896
    s_add_u32 m0, s65, 106496
    s_add_u32 s74, s74, 14336
    buffer_load_dwordx4 v6, s[44:47], s74 offen lds
    v_mfma_f32_32x32x16_bf16 v[208:223], v[236:239], v[36:39], v[208:223]
    ds_read_b64_tr_b16 v[228:229], v14 offset:18432
    ds_read_b64_tr_b16 v[230:231], v14 offset:18944
    v_mul_f32 v149, v149, v254
    v_mul_f32 v150, v150, v254
    v_mul_f32 v151, v151, v254
    v_mul_f32 v152, v152, v254
    v_mul_f32 v153, v153, v254
    v_mul_f32 v154, v154, v254
    v_mul_f32 v155, v155, v254
    v_cndmask_b32 v254, v254, 0, s[92:93]
    v_cvt_pk_bf16_f32 v144, v144, v145
    v_cvt_pk_bf16_f32 v145, v146, v147
    v_cvt_pk_bf16_f32 v146, v148, v149
    v_cvt_pk_bf16_f32 v147, v150, v151
    s_waitcnt lgkmcnt(0)
    v_mfma_f32_32x32x16_bf16 v[192:207], v[224:227], v[40:43], v[192:207]
    s_setprio 2
    ds_read_b64_tr_b16 v[232:233], v15 offset:16384
    ds_read_b64_tr_b16 v[234:235], v15 offset:16896
    s_add_u32 m0, s65, 114688
    s_add_u32 s74, s74, 14336
    buffer_load_dwordx4 v6, s[44:47], s74 offen lds
    v_mfma_f32_32x32x16_bf16 v[208:223], v[228:231], v[40:43], v[208:223]
    ds_read_b64_tr_b16 v[236:237], v15 offset:18432
    ds_read_b64_tr_b16 v[238:239], v15 offset:18944
    v_mfma_f32_16x16x32_bf16 v[244:247], v[28:31], v[228:231], 0
    v_and_b32 v144, s4, v144
    buffer_store_dwordx4 v[144:147], v1, s[40:43], s80 offen sc1
    v_fma_f32 v156, v156, v254, v255
    v_mul_f32 v157, v157, v254
    v_mul_f32 v158, v158, v254
    v_mul_f32 v159, v159, v254
    v_cvt_pk_bf16_f32 v148, v152, v153
    v_cvt_pk_bf16_f32 v149, v154, v155
    v_cvt_pk_bf16_f32 v150, v156, v157
    v_cvt_pk_bf16_f32 v151, v158, v159
    v_and_b32 v148, s4, v148
    buffer_store_dwordx4 v[148:151], v1, s[40:43], s80 offen offset:1024 sc1
    s_waitcnt lgkmcnt(0)
    v_mfma_f32_32x32x16_bf16 v[192:207], v[232:235], v[44:47], v[192:207]
    ds_read_b64_tr_b16 v[224:225], v12 offset:32768
    ds_read_b64_tr_b16 v[226:227], v12 offset:33280
    v_mfma_f32_32x32x16_bf16 v[208:223], v[236:239], v[44:47], v[208:223]
    ds_read_b64_tr_b16 v[228:229], v12 offset:34816
    ds_read_b64_tr_b16 v[230:231], v12 offset:35328
    s_mul_i32 s80, s70, 56
    s_sub_u32 s87, s61, s97
    s_lshl_b32 s87, s87, 1
    s_add_u32 s80, s80, s87
    s_add_u32 s80, s80, s63
    s_lshl_b32 s80, s80, 11
    s_add_u32 s80, s80, 0x600000
    v_mul_f32 v16, v160, v160
    v_mul_f32 v17, v161, v161
    v_mul_f32 v18, v162, v162
    v_mul_f32 v19, v163, v163
    v_mul_f32 v20, v164, v164
    v_mul_f32 v21, v165, v165
    v_mul_f32 v22, v166, v166
    v_mul_f32 v23, v167, v167
    v_fma_f32 v16, v16, v25, v24
    v_fma_f32 v17, v17, v25, v24
    s_waitcnt lgkmcnt(0)
    v_mfma_f32_32x32x16_bf16 v[192:207], v[224:227], v[48:51], v[192:207]
    s_setprio 1
    ds_read_b64_tr_b16 v[232:233], v13 offset:32768
    ds_read_b64_tr_b16 v[234:235], v13 offset:33280
    v_mfma_f32_32x32x16_bf16 v[208:223], v[228:231], v[48:51], v[208:223]
    ds_read_b64_tr_b16 v[236:237], v13 offset:34816
    ds_read_b64_tr_b16 v[238:239], v13 offset:35328
    v_mfma_f32_16x16x32_bf16 v[240:243], v[28:31], v[224:227], v[240:243]
    v_fma_f32 v18, v18, v25, v24
    v_fma_f32 v19, v19, v25, v24
    v_fma_f32 v20, v20, v25, v24
    v_fma_f32 v21, v21, v25, v24
    v_fma_f32 v22, v22, v25, v24
    v_fma_f32 v23, v23, v25, v24
    v_mul_f32 v16, v16, v160
    v_mul_f32 v17, v17, v161
    v_mul_f32 v18, v18, v162
    v_mul_f32 v19, v19, v163
    v_mul_f32 v20, v20, v164
    v_mul_f32 v21, v21, v165
    s_waitcnt lgkmcnt(0)
    v_mfma_f32_32x32x16_bf16 v[192:207], v[232:235], v[52:55], v[192:207]
    ds_read_b64_tr_b16 v[224:225], v14 offset:32768
    ds_read_b64_tr_b16 v[226:227], v14 offset:33280
    v_mfma_f32_32x32x16_bf16 v[208:223], v[236:239], v[52:55], v[208:223]
    ds_read_b64_tr_b16 v[228:229], v14 offset:34816
    ds_read_b64_tr_b16 v[230:231], v14 offset:35328
    v_mul_f32 v22, v22, v166
    v_mul_f32 v23, v23, v167
    v_exp_f32 v16, v16
    v_exp_f32 v17, v17
    v_exp_f32 v18, v18
    v_exp_f32 v19, v19
    v_exp_f32 v20, v20
    s_waitcnt lgkmcnt(0)
    v_mfma_f32_32x32x16_bf16 v[192:207], v[224:227], v[56:59], v[192:207]
    s_setprio 0
    ds_read_b64_tr_b16 v[232:233], v15 offset:32768
    ds_read_b64_tr_b16 v[234:235], v15 offset:33280
    v_mfma_f32_32x32x16_bf16 v[208:223], v[228:231], v[56:59], v[208:223]
    ds_read_b64_tr_b16 v[236:237], v15 offset:34816
    ds_read_b64_tr_b16 v[238:239], v15 offset:35328
    v_mfma_f32_16x16x32_bf16 v[244:247], v[28:31], v[228:231], v[244:247]
    v_exp_f32 v21, v21
    v_exp_f32 v22, v22
    v_exp_f32 v23, v23
    v_mul_f32 v160, v160, v176
    v_mul_f32 v161, v161, v177
    v_mul_f32 v162, v162, v178
    v_mul_f32 v163, v163, v179
    v_mul_f32 v164, v164, v180
    v_mul_f32 v165, v165, v181
    v_add_u32 v12, 0xfffe6000, v12
    s_waitcnt lgkmcnt(0)
    v_mfma_f32_32x32x16_bf16 v[192:207], v[232:235], v[60:63], v[192:207]
    ds_read_b64_tr_b16 v[224:225], v12
    ds_read_b64_tr_b16 v[226:227], v12 offset:512
    v_mfma_f32_32x32x16_bf16 v[208:223], v[236:239], v[60:63], v[208:223]
    ds_read_b64_tr_b16 v[228:229], v12 offset:2048
    ds_read_b64_tr_b16 v[230:231], v12 offset:2560
    v_mul_f32 v166, v166, v182
    v_mul_f32 v167, v167, v183
    v_fma_f32 v16, v16, v26, v26
    v_fma_f32 v17, v17, v26, v26
    v_fma_f32 v18, v18, v26, v26
    v_fma_f32 v19, v19, v26, v26
    v_fma_f32 v20, v20, v26, v26
    v_fma_f32 v21, v21, v26, v26
    v_fma_f32 v22, v22, v26, v26
    v_fma_f32 v23, v23, v26, v26
    v_rcp_f32 v16, v16
    v_add_u32 v13, 0xfffe6000, v13
    s_waitcnt vmcnt(10)
    s_waitcnt lgkmcnt(0)
    s_barrier
    v_mfma_f32_32x32x16_bf16 v[192:207], v[224:227], v[64:67], v[192:207]
    s_setprio 3
    ds_read_b64_tr_b16 v[232:233], v13
    ds_read_b64_tr_b16 v[234:235], v13 offset:512
    v_mfma_f32_32x32x16_bf16 v[208:223], v[228:231], v[64:67], v[208:223]
    ds_read_b64_tr_b16 v[236:237], v13 offset:2048
    ds_read_b64_tr_b16 v[238:239], v13 offset:2560
    v_mfma_f32_16x16x32_bf16 v[240:243], v[28:31], v[224:227], v[240:243]
    v_rcp_f32 v17, v17
    v_rcp_f32 v18, v18
    v_rcp_f32 v19, v19
    v_rcp_f32 v20, v20
    v_rcp_f32 v21, v21
    v_rcp_f32 v22, v22
    v_add_u32 v14, 0xfffe6000, v14
    s_waitcnt lgkmcnt(0)
    v_mfma_f32_32x32x16_bf16 v[192:207], v[232:235], v[68:71], v[192:207]
    ds_read_b64_tr_b16 v[224:225], v14
    ds_read_b64_tr_b16 v[226:227], v14 offset:512
    v_mfma_f32_32x32x16_bf16 v[208:223], v[236:239], v[68:71], v[208:223]
    ds_read_b64_tr_b16 v[228:229], v14 offset:2048
    ds_read_b64_tr_b16 v[230:231], v14 offset:2560
    v_rcp_f32 v23, v23
    v_mul_f32 v160, v160, v16
    v_mul_f32 v161, v161, v17
    v_mul_f32 v162, v162, v18
    v_mul_f32 v163, v163, v19
    v_mul_f32 v164, v164, v20
    v_mul_f32 v165, v165, v21
    v_mul_f32 v166, v166, v22
    v_mul_f32 v167, v167, v23
    v_cvt_pk_bf16_f32 v176, v160, v161
    v_add_u32 v15, 0xfffe6000, v15
    s_waitcnt lgkmcnt(0)
    v_mfma_f32_32x32x16_bf16 v[192:207], v[224:227], v[72:75], v[192:207]
    ds_read_b64_tr_b16 v[232:233], v15
    ds_read_b64_tr_b16 v[234:235], v15 offset:512
    v_mfma_f32_32x32x16_bf16 v[208:223], v[228:231], v[72:75], v[208:223]
    ds_read_b64_tr_b16 v[236:237], v15 offset:2048
    ds_read_b64_tr_b16 v[238:239], v15 offset:2560
    v_mfma_f32_16x16x32_bf16 v[244:247], v[28:31], v[228:231], v[244:247]
    v_cvt_pk_bf16_f32 v177, v162, v163
    v_cvt_pk_bf16_f32 v178, v164, v165
    v_cvt_pk_bf16_f32 v179, v166, v167
    v_mul_f32 v16, v168, v168
    v_mul_f32 v17, v169, v169
    v_mul_f32 v18, v170, v170
    v_mul_f32 v19, v171, v171
    s_waitcnt lgkmcnt(0)
    v_mfma_f32_32x32x16_bf16 v[192:207], v[232:235], v[76:79], v[192:207]
    s_setprio 2
    ds_read_b64_tr_b16 v[224:225], v12 offset:16384
    ds_read_b64_tr_b16 v[226:227], v12 offset:16896
    v_mfma_f32_32x32x16_bf16 v[208:223], v[236:239], v[76:79], v[208:223]
    ds_read_b64_tr_b16 v[228:229], v12 offset:18432
    ds_read_b64_tr_b16 v[230:231], v12 offset:18944
    v_mul_f32 v20, v172, v172
    v_mul_f32 v21, v173, v173
    v_mul_f32 v22, v174, v174
    v_mul_f32 v23, v175, v175
    v_fma_f32 v16, v16, v25, v24
    v_fma_f32 v17, v17, v25, v24
    v_fma_f32 v18, v18, v25, v24
    v_fma_f32 v19, v19, v25, v24
    v_fma_f32 v20, v20, v25, v24
    v_fma_f32 v21, v21, v25, v24
    v_fma_f32 v22, v22, v25, v24
    v_fma_f32 v23, v23, v25, v24
    s_waitcnt lgkmcnt(0)
    v_mfma_f32_32x32x16_bf16 v[192:207], v[224:227], v[80:83], v[192:207]
    ds_read_b64_tr_b16 v[232:233], v13 offset:16384
    ds_read_b64_tr_b16 v[234:235], v13 offset:16896
    v_mfma_f32_32x32x16_bf16 v[208:223], v[228:231], v[80:83], v[208:223]
    ds_read_b64_tr_b16 v[236:237], v13 offset:18432
    ds_read_b64_tr_b16 v[238:239], v13 offset:18944
    v_mfma_f32_16x16x32_bf16 v[240:243], v[28:31], v[224:227], v[240:243]
    v_mul_f32 v16, v16, v168
    v_mul_f32 v17, v17, v169
    v_mul_f32 v18, v18, v170
    v_mul_f32 v19, v19, v171
    v_mul_f32 v20, v20, v172
    v_mul_f32 v21, v21, v173
    v_mul_f32 v22, v22, v174
    v_mul_f32 v23, v23, v175
    v_exp_f32 v16, v16
    v_exp_f32 v17, v17
    s_waitcnt lgkmcnt(0)
    v_mfma_f32_32x32x16_bf16 v[192:207], v[232:235], v[84:87], v[192:207]
    s_setprio 1
    ds_read_b64_tr_b16 v[224:225], v14 offset:16384
    ds_read_b64_tr_b16 v[226:227], v14 offset:16896
    v_mfma_f32_32x32x16_bf16 v[208:223], v[236:239], v[84:87], v[208:223]
    ds_read_b64_tr_b16 v[228:229], v14 offset:18432
    ds_read_b64_tr_b16 v[230:231], v14 offset:18944
    v_exp_f32 v18, v18
    v_exp_f32 v19, v19
    v_exp_f32 v20, v20
    v_exp_f32 v21, v21
    v_exp_f32 v22, v22
    v_exp_f32 v23, v23
    s_waitcnt lgkmcnt(0)
    v_mfma_f32_32x32x16_bf16 v[192:207], v[224:227], v[88:91], v[192:207]
    ds_read_b64_tr_b16 v[232:233], v15 offset:16384
    ds_read_b64_tr_b16 v[234:235], v15 offset:16896
    v_mfma_f32_32x32x16_bf16 v[208:223], v[228:231], v[88:91], v[208:223]
    ds_read_b64_tr_b16 v[236:237], v15 offset:18432
    ds_read_b64_tr_b16 v[238:239], v15 offset:18944
    v_mfma_f32_16x16x32_bf16 v[244:247], v[28:31], v[228:231], v[244:247]
    v_mul_f32 v168, v168, v184
    v_mul_f32 v169, v169, v185
    v_mul_f32 v170, v170, v186
    v_mul_f32 v171, v171, v187
    v_mul_f32 v172, v172, v188
    v_mul_f32 v173, v173, v189
    v_mul_f32 v174, v174, v190
    v_mul_f32 v175, v175, v191
    v_fma_f32 v16, v16, v26, v26
    v_fma_f32 v17, v17, v26, v26
    v_fma_f32 v18, v18, v26, v26
    v_fma_f32 v19, v19, v26, v26
    s_waitcnt lgkmcnt(0)
    v_mfma_f32_32x32x16_bf16 v[192:207], v[232:235], v[92:95], v[192:207]
    ds_read_b64_tr_b16 v[224:225], v12 offset:40960
    ds_read_b64_tr_b16 v[226:227], v12 offset:41472
    v_mfma_f32_32x32x16_bf16 v[208:223], v[236:239], v[92:95], v[208:223]
    ds_read_b64_tr_b16 v[228:229], v12 offset:43008
    ds_read_b64_tr_b16 v[230:231], v12 offset:43520
    v_fma_f32 v20, v20, v26, v26
    v_fma_f32 v21, v21, v26, v26
    v_fma_f32 v22, v22, v26, v26
    v_fma_f32 v23, v23, v26, v26
    v_rcp_f32 v16, v16
    v_rcp_f32 v17, v17
    v_rcp_f32 v18, v18
    v_rcp_f32 v19, v19
    s_waitcnt lgkmcnt(0)
    v_mfma_f32_32x32x16_bf16 v[192:207], v[224:227], v[96:99], v[192:207]
    s_setprio 0
    ds_read_b64_tr_b16 v[232:233], v13 offset:40960
    ds_read_b64_tr_b16 v[234:235], v13 offset:41472
    v_mfma_f32_32x32x16_bf16 v[208:223], v[228:231], v[96:99], v[208:223]
    ds_read_b64_tr_b16 v[236:237], v13 offset:43008
    ds_read_b64_tr_b16 v[238:239], v13 offset:43520
    v_mfma_f32_16x16x32_bf16 v[240:243], v[28:31], v[224:227], v[240:243]
    v_rcp_f32 v20, v20
    v_rcp_f32 v21, v21
    v_rcp_f32 v22, v22
    v_rcp_f32 v23, v23
    v_mul_f32 v168, v168, v16
    v_mul_f32 v169, v169, v17
    v_mul_f32 v170, v170, v18
    v_mul_f32 v171, v171, v19
    s_waitcnt lgkmcnt(0)
    v_mfma_f32_32x32x16_bf16 v[192:207], v[232:235], v[100:103], v[192:207]
    ds_read_b64_tr_b16 v[224:225], v14 offset:40960
    ds_read_b64_tr_b16 v[226:227], v14 offset:41472
    v_mfma_f32_32x32x16_bf16 v[208:223], v[236:239], v[100:103], v[208:223]
    ds_read_b64_tr_b16 v[228:229], v14 offset:43008
    ds_read_b64_tr_b16 v[230:231], v14 offset:43520
    v_mul_f32 v172, v172, v20
    v_mul_f32 v173, v173, v21
    v_mul_f32 v174, v174, v22
    v_mul_f32 v175, v175, v23
    v_cvt_pk_bf16_f32 v184, v168, v169
    v_cvt_pk_bf16_f32 v185, v170, v171
    v_cvt_pk_bf16_f32 v186, v172, v173
    v_cvt_pk_bf16_f32 v187, v174, v175
    s_waitcnt vmcnt(0)
    s_waitcnt lgkmcnt(0)
    s_barrier
    s_cmp_eq_u32 s62, 0
    s_cbranch_scc0 L_G10
    buffer_store_dword v248, v7, s[40:43], s83 offen sc1
L_G10:
    buffer_store_dwordx4 v[176:179], v1, s[40:43], s80 offen sc1
    s_lshr_b32 s86, s71, 1
    s_lshl_b32 s86, s86, 6
    s_lshl_b32 s87, s72, 2
    s_add_u32 s87, s87, s86
    s_add_u32 s86, s86, 512
    s_lshr_b32 s88, s71, 2
    s_lshl_b32 s88, s88, 6
    s_add_u32 s88, s88, 960
    v_mov_b32 v250, s88
    v_mov_b32 v254, s86
    v_cmp_gt_u32 vcc, 16, v0
    s_nop 1
    v_cndmask_b32 v250, v250, v254, vcc
    v_lshl_add_u32 v250, v0, 2, v250
    v_mov_b32 v254, s87
    v_cndmask_b32 v250, v250, v254, s[92:93]
    v_lshlrev_b32 v250, 5, v250
    v_or_b32 v250, s3, v250
    s_mov_b32 s10, 0xf00000
    v_mfma_f32_32x32x16_bf16 v[192:207], v[224:227], v[104:107], v[192:207]
    s_setprio 3
    ds_read_b64_tr_b16 v[232:233], v15 offset:40960
    ds_read_b64_tr_b16 v[234:235], v15 offset:41472
    v_mfma_f32_32x32x16_bf16 v[208:223], v[228:231], v[104:107], v[208:223]
    ds_read_b64_tr_b16 v[236:237], v15 offset:43008
    ds_read_b64_tr_b16 v[238:239], v15 offset:43520
    v_mfma_f32_16x16x32_bf16 v[244:247], v[28:31], v[228:231], v[244:247]
    buffer_store_dwordx4 v[184:187], v1, s[40:43], s80 offen offset:1024 sc1
    s_waitcnt lgkmcnt(0)
    v_mfma_f32_32x32x16_bf16 v[192:207], v[232:235], v[108:111], v[192:207]
    ds_read_b64_tr_b16 v[224:225], v12 offset:57344
    ds_read_b64_tr_b16 v[226:227], v12 offset:57856
    v_mfma_f32_32x32x16_bf16 v[208:223], v[236:239], v[108:111], v[208:223]
    ds_read_b64_tr_b16 v[228:229], v12 offset:59392
    ds_read_b64_tr_b16 v[230:231], v12 offset:59904
    s_waitcnt lgkmcnt(0)
    v_mfma_f32_32x32x16_bf16 v[192:207], v[224:227], v[112:115], v[192:207]
    ds_read_b64_tr_b16 v[232:233], v13 offset:57344
    ds_read_b64_tr_b16 v[234:235], v13 offset:57856
    v_mfma_f32_32x32x16_bf16 v[208:223], v[228:231], v[112:115], v[208:223]
    ds_read_b64_tr_b16 v[236:237], v13 offset:59392
    ds_read_b64_tr_b16 v[238:239], v13 offset:59904
    v_mfma_f32_16x16x32_bf16 v[240:243], v[28:31], v[224:227], v[240:243]
    s_lshl_b32 s86, s63, 12
    v_add_u32 v32, s86, v1
    v_add_u32 v33, 0x10000, v32
    v_add_u32 v34, 0x20000, v32
    v_lshrrev_b32 v48, 5, v0
    v_bfe_u32 v9, v0, 2, 2
    v_lshl_add_u32 v9, v48, 2, v9
    v_lshlrev_b32 v9, 7, v9
    s_waitcnt lgkmcnt(0)
    v_mfma_f32_32x32x16_bf16 v[192:207], v[232:235], v[116:119], v[192:207]
    s_setprio 2
    ds_read_b64_tr_b16 v[224:225], v14 offset:57344
    ds_read_b64_tr_b16 v[226:227], v14 offset:57856
    v_mfma_f32_32x32x16_bf16 v[208:223], v[236:239], v[116:119], v[208:223]
    ds_read_b64_tr_b16 v[228:229], v14 offset:59392
    ds_read_b64_tr_b16 v[230:231], v14 offset:59904
    s_lshl_b32 s86, s78, 11
    v_add_u32 v35, 0, v10
    v_xor_b32 v35, v35, v11
    v_add3_u32 v35, v35, v9, s86
    v_add_u32 v36, 0x10000, v35
    v_add_u32 v37, 0x20000, v35
    v_xor_b32 v38, 64, v35
    v_xor_b32 v39, 64, v36
    v_xor_b32 v40, 64, v37
    s_waitcnt lgkmcnt(0)
    v_mfma_f32_32x32x16_bf16 v[192:207], v[224:227], v[120:123], v[192:207]
    ds_read_b64_tr_b16 v[232:233], v15 offset:57344
    ds_read_b64_tr_b16 v[234:235], v15 offset:57856
    v_mfma_f32_32x32x16_bf16 v[208:223], v[228:231], v[120:123], v[208:223]
    ds_read_b64_tr_b16 v[236:237], v15 offset:59392
    ds_read_b64_tr_b16 v[238:239], v15 offset:59904
    v_mfma_f32_16x16x32_bf16 v[244:247], v[28:31], v[228:231], v[244:247]
    s_lshr_b32 s86, s76, 1
    s_lshl_b32 s86, s86, 7
    s_add_u32 s86, s86, 2048
    v_min_u32 v41, 11, v0
    v_lshl_add_u32 v41, v41, 2, s86
    v_min_u32 v42, 27, v0
    v_lshl_add_u32 v42, v42, 2, s86
    v_lshlrev_b32 v41, 5, v41
    v_or_b32 v41, s3, v41
    v_lshlrev_b32 v42, 5, v42
    v_or_b32 v42, s3, v42
    v_add_u32 v12, 0x14000, v12
    s_waitcnt lgkmcnt(0)
    v_mfma_f32_32x32x16_bf16 v[192:207], v[232:235], v[124:127], v[192:207]
    s_setprio 1
    ds_read_b64_tr_b16 v[224:225], v12
    ds_read_b64_tr_b16 v[226:227], v12 offset:512
    v_mfma_f32_32x32x16_bf16 v[208:223], v[236:239], v[124:127], v[208:223]
    ds_read_b64_tr_b16 v[228:229], v12 offset:2048
    ds_read_b64_tr_b16 v[230:231], v12 offset:2560
    s_lshl_b32 s88, s76, 1
    s_add_u32 s88, s88, s79
    s_mul_i32 s75, s88, 112
    s_mul_i32 s87, s78, 12
    s_add_u32 s75, s75, s87
    s_lshl_b32 s75, s75, 10
    s_add_u32 s75, s75, 0x600000
    s_lshl_b32 s89, s78, 8
    s_add_u32 s89, s89, s88
    s_lshl_b32 s89, s89, 11
    s_cmp_ge_u32 s2, 224
    s_cselect_b32 s75, 0x70000000, s75
    s_cselect_b32 s89, 0x70000000, s89
    v_add_u32 v13, 0x14000, v13
    s_waitcnt lgkmcnt(0)
    s_cmp_eq_u32 s62, 0
    s_cbranch_scc0 L_G11
    buffer_load_dword v253, v250, s[40:43], s10 offen sc1
L_G11:
    v_mfma_f32_32x32x16_bf16 v[192:207], v[224:227], v[128:131], v[192:207]
    ds_read_b64_tr_b16 v[232:233], v13
    ds_read_b64_tr_b16 v[234:235], v13 offset:512
    v_mfma_f32_32x32x16_bf16 v[208:223], v[228:231], v[128:131], v[208:223]
    ds_read_b64_tr_b16 v[236:237], v13 offset:2048
    ds_read_b64_tr_b16 v[238:239], v13 offset:2560
    v_mfma_f32_16x16x32_bf16 v[240:243], v[28:31], v[224:227], v[240:243]
    v_lshrrev_b32 v48, 3, v0
    s_lshl_b32 s86, s62, 3
    v_add_u32 v48, s86, v48
    v_and_b32 v49, 7, v0
    v_mul_u32_u24 v43, 896, v48
    v_lshl_add_u32 v43, v49, 4, v43
    v_mul_u32_u24 v44, 272, v48
    v_lshl_add_u32 v44, v49, 5, v44
    s_mul_i32 s91, s76, 57344
    s_lshl_b32 s86, s77, 7
    s_add_u32 s91, s91, s86
    v_add_u32 v14, 0x14000, v14
    s_waitcnt lgkmcnt(0)
    v_mfma_f32_32x32x16_bf16 v[192:207], v[232:235], v[132:135], v[192:207]
    ds_read_b64_tr_b16 v[224:225], v14
    ds_read_b64_tr_b16 v[226:227], v14 offset:512
    v_mfma_f32_32x32x16_bf16 v[208:223], v[236:239], v[132:135], v[208:223]
    ds_read_b64_tr_b16 v[228:229], v14 offset:2048
    ds_read_b64_tr_b16 v[230:231], v14 offset:2560
    v_and_b32 v45, 31, v0
    v_mul_u32_u24 v45, 272, v45
    v_lshrrev_b32 v48, 5, v0
    v_lshl_add_u32 v45, v48, 4, v45
    s_mul_i32 s86, s62, 8704
    v_add_u32 v45, s86, v45
    s_lshl_b32 s11, s71, 6
    s_add_u32 s11, s11, s82
    s_lshl_b32 s11, s11, 11
    s_lshl_b32 s101, s63, 10
    s_add_u32 s101, s101, s11
    v_add_u32 v15, 0x14000, v15
    s_waitcnt lgkmcnt(0)
    v_mfma_f32_32x32x16_bf16 v[192:207], v[224:227], v[136:139], v[192:207]
    s_setprio 0
    ds_read_b64_tr_b16 v[232:233], v15
    ds_read_b64_tr_b16 v[234:235], v15 offset:512
    v_mfma_f32_32x32x16_bf16 v[208:223], v[228:231], v[136:139], v[208:223]
    ds_read_b64_tr_b16 v[236:237], v15 offset:2048
    ds_read_b64_tr_b16 v[238:239], v15 offset:2560
    v_mfma_f32_16x16x32_bf16 v[244:247], v[28:31], v[228:231], v[244:247]
    s_lshl_b32 s86, s64, 2
    s_lshl_b32 s87, s63, 9
    s_sub_u32 s86, s86, s87
    s_add_u32 s86, s86, 3072
    v_add_u32 v249, s86, v249
    s_waitcnt lgkmcnt(0)
    v_mfma_f32_32x32x16_bf16 v[192:207], v[232:235], v[140:143], v[192:207]
    ds_write_b32 v249, v240
    v_mfma_f32_32x32x16_bf16 v[208:223], v[236:239], v[140:143], v[208:223]
    ds_write_b32 v249, v244 offset:512
    v_and_b32 v249, 0xfffffff0, v249
L_JOIN:
    s_setprio 0
    s_cmp_lg_u32 s62, 0
    s_cbranch_scc1 L_OK23
    s_waitcnt vmcnt(0)
    s_mov_b32 s90, 100000
L_SP23:
    v_and_b32 v253, 0xff, v253
    v_cmp_ne_u32 vcc, 1, v253
    s_nop 1
    s_cbranch_vccz L_OK23
    s_sleep 4
    buffer_load_dword v253, v250, s[40:43], s10 offen sc1
    s_sub_u32 s90, s90, 1
    s_waitcnt vmcnt(0)
    s_cbranch_scc0 L_SP23
L_OK23:
    s_waitcnt lgkmcnt(0)
    s_barrier
    ds_read_b128 v[224:227], v249
    ds_read_b128 v[228:231], v249 offset:512
    buffer_load_dwordx4 v[144:147], v1, s[40:43], s11 offen sc1
    buffer_load_dwordx4 v[148:151], v1, s[40:43], s11 offen offset:1024 sc1
    buffer_load_dwordx4 v[128:131], v1, s[40:43], s81 offen sc1
    buffer_load_dwordx4 v[132:135], v1, s[40:43], s81 offen offset:1024 sc1
    s_add_u32 m0, s65, 122880
    s_add_u32 s74, s74, 14336
    buffer_load_dwordx4 v1, s[40:43], s73 offen sc1 lds
    s_add_u32 m0, s65, 131072
    s_add_u32 s73, s73, 8192
    buffer_load_dwordx4 v1, s[40:43], s73 offen sc1 lds
    s_add_u32 m0, s65, 139264
    s_add_u32 s73, s73, 8192
    buffer_load_dwordx4 v1, s[40:43], s73 offen sc1 lds
    s_add_u32 m0, s65, 147456
    s_add_u32 s73, s73, 8192
    buffer_load_dwordx4 v1, s[40:43], s73 offen sc1 lds
    s_waitcnt lgkmcnt(1)
    v_add_f32 v224, v224, v225
    v_add_f32 v226, v226, v227
    s_waitcnt lgkmcnt(0)
    v_add_f32 v228, v228, v229
    v_add_f32 v230, v230, v231
    v_add_f32 v224, v224, v226
    v_mov_b32 v227, 0
    v_add_f32 v228, v228, v230
    v_mov_b32 v231, 0
    v_and_b32 v225, 0xffff0000, v224
    v_mov_b32 v226, 0
    v_and_b32 v229, 0xffff0000, v228
    v_mov_b32 v230, 0
    v_sub_f32 v224, v224, v225
    v_sub_f32 v228, v228, v229
    v_cvt_pk_bf16_f32 v224, v224, v225
    v_cvt_pk_bf16_f32 v228, v228, v229
    v_mov_b32 v225, 0
    v_mov_b32 v229, 0
    s_nop 0
    v_mfma_f32_32x32x16_bf16 v[192:207], v[224:227], v[2:5], v[192:207]
    v_mfma_f32_32x32x16_bf16 v[208:223], v[228:231], v[2:5], v[208:223]
    s_mul_i32 s80, s70, 56
    s_lshl_b32 s87, s61, 1
    s_add_u32 s80, s80, s87
    s_add_u32 s80, s80, s63
    s_lshl_b32 s80, s80, 11
    s_add_u32 s80, s80, 0x60c000
    s_nop 4
    v_pk_mul_f32 v[16:17], v[192:193], v[192:193]
    v_pk_mul_f32 v[18:19], v[194:195], v[194:195]
    v_pk_mul_f32 v[20:21], v[196:197], v[196:197]
    v_pk_mul_f32 v[22:23], v[198:199], v[198:199]
    v_pk_fma_f32 v[16:17], v[16:17], v[24:25], v[24:25] op_sel:[0,1,0] op_sel_hi:[1,1,0]
    v_pk_fma_f32 v[18:19], v[18:19], v[24:25], v[24:25] op_sel:[0,1,0] op_sel_hi:[1,1,0]
    v_pk_fma_f32 v[20:21], v[20:21], v[24:25], v[24:25] op_sel:[0,1,0] op_sel_hi:[1,1,0]
    v_pk_fma_f32 v[22:23], v[22:23], v[24:25], v[24:25] op_sel:[0,1,0] op_sel_hi:[1,1,0]
    v_pk_mul_f32 v[16:17], v[16:17], v[192:193]
    v_pk_mul_f32 v[18:19], v[18:19], v[194:195]
    v_pk_mul_f32 v[20:21], v[20:21], v[196:197]
    v_pk_mul_f32 v[22:23], v[22:23], v[198:199]
    v_exp_f32 v16, v16
    v_exp_f32 v17, v17
    v_exp_f32 v18, v18
    v_exp_f32 v19, v19
    v_exp_f32 v20, v20
    v_exp_f32 v21, v21
    v_exp_f32 v22, v22
    v_exp_f32 v23, v23
    v_pk_mul_f32 v[192:193], v[192:193], v[208:209]
    v_pk_mul_f32 v[194:195], v[194:195], v[210:211]
    v_pk_mul_f32 v[196:197], v[196:197], v[212:213]
    v_pk_mul_f32 v[198:199], v[198:199], v[214:215]
    v_pk_fma_f32 v[16:17], v[16:17], v[26:27], v[26:27] op_sel_hi:[1,0,0]
    v_pk_fma_f32 v[18:19], v[18:19], v[26:27], v[26:27] op_sel_hi:[1,0,0]
    v_pk_fma_f32 v[20:21], v[20:21], v[26:27], v[26:27] op_sel_hi:[1,0,0]
    v_pk_fma_f32 v[22:23], v[22:23], v[26:27], v[26:27] op_sel_hi:[1,0,0]
    v_rcp_f32 v16, v16
    v_rcp_f32 v17, v17
    v_rcp_f32 v18, v18
    v_rcp_f32 v19, v19
    v_rcp_f32 v20, v20
    v_rcp_f32 v21, v21
    v_rcp_f32 v22, v22
    v_rcp_f32 v23, v23
    v_pk_mul_f32 v[192:193], v[192:193], v[16:17]
    v_pk_mul_f32 v[194:195], v[194:195], v[18:19]
    v_pk_mul_f32 v[196:197], v[196:197], v[20:21]
    v_pk_mul_f32 v[198:199], v[198:199], v[22:23]
    v_cvt_pk_bf16_f32 v208, v192, v193
    v_cvt_pk_bf16_f32 v209, v194, v195
    v_cvt_pk_bf16_f32 v210, v196, v197
    v_cvt_pk_bf16_f32 v211, v198, v199
    v_pk_mul_f32 v[16:17], v[200:201], v[200:201]
    v_pk_mul_f32 v[18:19], v[202:203], v[202:203]
    v_pk_mul_f32 v[20:21], v[204:205], v[204:205]
    v_pk_mul_f32 v[22:23], v[206:207], v[206:207]
    v_pk_fma_f32 v[16:17], v[16:17], v[24:25], v[24:25] op_sel:[0,1,0] op_sel_hi:[1,1,0]
    v_pk_fma_f32 v[18:19], v[18:19], v[24:25], v[24:25] op_sel:[0,1,0] op_sel_hi:[1,1,0]
    v_pk_fma_f32 v[20:21], v[20:21], v[24:25], v[24:25] op_sel:[0,1,0] op_sel_hi:[1,1,0]
    v_pk_fma_f32 v[22:23], v[22:23], v[24:25], v[24:25] op_sel:[0,1,0] op_sel_hi:[1,1,0]
    v_pk_mul_f32 v[16:17], v[16:17], v[200:201]
    v_pk_mul_f32 v[18:19], v[18:19], v[202:203]
    v_pk_mul_f32 v[20:21], v[20:21], v[204:205]
    v_pk_mul_f32 v[22:23], v[22:23], v[206:207]
    v_exp_f32 v16, v16
    v_exp_f32 v17, v17
    v_exp_f32 v18, v18
    v_exp_f32 v19, v19
    v_exp_f32 v20, v20
    v_exp_f32 v21, v21
    v_exp_f32 v22, v22
    v_exp_f32 v23, v23
    v_pk_mul_f32 v[200:201], v[200:201], v[216:217]
    v_pk_mul_f32 v[202:203], v[202:203], v[218:219]
    v_pk_mul_f32 v[204:205], v[204:205], v[220:221]
    v_pk_mul_f32 v[206:207], v[206:207], v[222:223]
    v_pk_fma_f32 v[16:17], v[16:17], v[26:27], v[26:27] op_sel_hi:[1,0,0]
    v_pk_fma_f32 v[18:19], v[18:19], v[26:27], v[26:27] op_sel_hi:[1,0,0]
    v_pk_fma_f32 v[20:21], v[20:21], v[26:27], v[26:27] op_sel_hi:[1,0,0]
    v_pk_fma_f32 v[22:23], v[22:23], v[26:27], v[26:27] op_sel_hi:[1,0,0]
    v_rcp_f32 v16, v16
    v_rcp_f32 v17, v17
    v_rcp_f32 v18, v18
    v_rcp_f32 v19, v19
    v_rcp_f32 v20, v20
    v_rcp_f32 v21, v21
    v_rcp_f32 v22, v22
    v_rcp_f32 v23, v23
    v_pk_mul_f32 v[200:201], v[200:201], v[16:17]
    v_pk_mul_f32 v[202:203], v[202:203], v[18:19]
    v_pk_mul_f32 v[204:205], v[204:205], v[20:21]
    v_pk_mul_f32 v[206:207], v[206:207], v[22:23]
    v_cvt_pk_bf16_f32 v216, v200, v201
    v_cvt_pk_bf16_f32 v217, v202, v203
    v_cvt_pk_bf16_f32 v218, v204, v205
    v_cvt_pk_bf16_f32 v219, v206, v207
    s_waitcnt vmcnt(5)
    v_mfma_f32_32x32x16_bf16 v[72:87], v[128:131], v[144:147], 0
    s_waitcnt vmcnt(4)
    v_mfma_f32_32x32x16_bf16 v[72:87], v[132:135], v[148:151], v[72:87]
    s_add_u32 m0, s65, 0
    s_add_u32 s73, s73, 8192
    buffer_load_dwordx4 v1, s[40:43], s73 offen sc1 lds
    s_add_u32 m0, s65, 8192
    s_add_u32 s73, s73, 8192
    buffer_load_dwordx4 v1, s[40:43], s73 offen sc1 lds
    s_nop 5
    v_max3_f32 v48, v72, v73, v74
    v_max3_f32 v49, v75, v76, v77
    v_max3_f32 v50, v78, v79, v80
    v_max3_f32 v51, v81, v82, v83
    v_max3_f32 v48, v48, v84, v85
    v_max3_f32 v49, v49, v86, v87
    v_max3_f32 v48, v48, v49, v50
    v_max_f32 v48, v48, v51
    v_mov_b32 v49, v48
    s_nop 1
    v_permlane32_swap_b32 v48, v49
    v_max_f32 v48, v48, v49
    v_sub_f32 v48, 0xc2cc0000, v48
    v_cvt_pk_bf16_f32 v48, v48, 0
    v_cndmask_b32 v150, v150, v48, s[92:93]
    s_waitcnt vmcnt(2)
    s_barrier
    s_cmp_eq_u32 s62, 0
    s_cbranch_scc0 L_G24
    buffer_store_dword v248, v7, s[40:43], s84 offen sc1
L_G24:
    ds_read_b128 v[96:99], v33 offset:57344
    ds_read_b128 v[100:103], v33 offset:58368
    ds_read_b128 v[104:107], v33 offset:59392
    ds_read_b128 v[108:111], v33 offset:60416
    ds_read_b128 v[112:115], v34
    ds_read_b128 v[116:119], v34 offset:1024
    ds_read_b128 v[120:123], v34 offset:2048
    ds_read_b128 v[124:127], v34 offset:3072
    s_add_u32 m0, s65, 16384
    s_add_u32 s73, s73, 8192
    buffer_load_dwordx4 v1, s[40:43], s73 offen sc1 lds
    s_add_u32 m0, s65, 24576
    s_add_u32 s73, s73, 8192
    buffer_load_dwordx4 v1, s[40:43], s73 offen sc1 lds
    s_add_u32 m0, s65, 40960
    s_add_u32 s73, s73, 8192
    buffer_load_dwordx4 v1, s[40:43], s73 offen sc1 lds
    s_waitcnt lgkmcnt(7)
    v_mfma_f32_32x32x16_bf16 v[56:71], v[96:99], v[144:147], 0
    s_waitcnt lgkmcnt(6)
    v_mfma_f32_32x32x16_bf16 v[56:71], v[100:103], v[148:151], v[56:71]
    s_waitcnt lgkmcnt(0)
    v_mfma_f32_32x32x16_bf16 v[72:87], v[112:115], v[144:147], 0
    s_setprio 3
    ds_read_b128 v[128:131], v34 offset:8192
    ds_read_b128 v[132:135], v34 offset:9216
    s_add_u32 m0, s65, 49152
    s_add_u32 s73, s73, 8192
    buffer_load_dwordx4 v1, s[40:43], s73 offen sc1 lds
    s_add_u32 m0, s65, 57344
    s_add_u32 s73, s73, 8192
    buffer_load_dwordx4 v1, s[40:43], s73 offen sc1 lds
    s_nop 0
    v_exp_f32 v56, v56
    v_exp_f32 v57, v57
    v_exp_f32 v58, v58
    v_exp_f32 v59, v59
    v_cvt_pk_bf16_f32 v88, v56, v57
    v_exp_f32 v60, v60
    v_mfma_f32_32x32x16_bf16 v[72:87], v[116:119], v[148:151], v[72:87]
    ds_read_b128 v[136:139], v34 offset:10240
    ds_read_b128 v[140:143], v34 offset:11264
    s_add_u32 m0, s65, 65536
    s_add_u32 s73, s73, 8192
    buffer_load_dwordx4 v1, s[40:43], s73 offen sc1 lds
    v_exp_f32 v61, v61
    v_cvt_pk_bf16_f32 v89, v58, v59
    v_exp_f32 v62, v62
    v_exp_f32 v63, v63
    v_cvt_pk_bf16_f32 v90, v60, v61
    v_cvt_pk_bf16_f32 v91, v62, v63
    s_nop 0
    s_nop 0
    v_mfma_f32_32x32x16_bf16 v[12:27], v[104:107], v[88:91], 0
    s_waitcnt lgkmcnt(0)
    v_exp_f32 v64, v64
    v_exp_f32 v65, v65
    v_exp_f32 v66, v66
    v_exp_f32 v67, v67
    v_cvt_pk_bf16_f32 v92, v64, v65
    v_exp_f32 v68, v68
    v_exp_f32 v69, v69
    v_cvt_pk_bf16_f32 v93, v66, v67
    v_exp_f32 v70, v70
    v_exp_f32 v71, v71
    v_cvt_pk_bf16_f32 v94, v68, v69
    v_cvt_pk_bf16_f32 v95, v70, v71
    v_mfma_f32_32x32x16_bf16 v[56:71], v[128:131], v[144:147], 0
    s_setprio 1
    ds_read_b128 v[96:99], v34 offset:16384
    ds_read_b128 v[100:103], v34 offset:17408
    s_add_u32 m0, s65, 81920
    s_add_u32 s73, s73, 8192
    buffer_load_dwordx4 v1, s[40:43], s73 offen sc1 lds
    v_exp_f32 v72, v72
    v_exp_f32 v73, v73
    v_exp_f32 v74, v74
    v_mfma_f32_32x32x16_bf16 v[12:27], v[108:111], v[92:95], v[12:27]
    ds_read_b128 v[104:107], v34 offset:18432
    s_add_u32 m0, s65, 90112
    s_add_u32 s73, s73, 8192
    buffer_load_dwordx4 v1, s[40:43], s73 offen sc1 lds
    v_exp_f32 v75, v75
    v_cvt_pk_bf16_f32 v88, v72, v73
    v_exp_f32 v76, v76
    v_exp_f32 v77, v77
    v_mfma_f32_32x32x16_bf16 v[56:71], v[132:135], v[148:151], v[56:71]
    ds_read_b128 v[108:111], v34 offset:19456
    v_cvt_pk_bf16_f32 v89, v74, v75
    v_exp_f32 v78, v78
    v_exp_f32 v79, v79
    v_cvt_pk_bf16_f32 v90, v76, v77
    v_cvt_pk_bf16_f32 v91, v78, v79
    s_nop 0
    s_nop 0
    v_mfma_f32_32x32x16_bf16 v[12:27], v[120:123], v[88:91], v[12:27]
    s_waitcnt lgkmcnt(0)
    v_exp_f32 v80, v80
    v_exp_f32 v81, v81
    v_exp_f32 v82, v82
    v_exp_f32 v83, v83
    v_cvt_pk_bf16_f32 v92, v80, v81
    v_exp_f32 v84, v84
    v_exp_f32 v85, v85
    v_cvt_pk_bf16_f32 v93, v82, v83
    v_exp_f32 v86, v86
    v_exp_f32 v87, v87
    v_cvt_pk_bf16_f32 v94, v84, v85
    v_cvt_pk_bf16_f32 v95, v86, v87
    s_waitcnt vmcnt(6)
    s_barrier
    v_mfma_f32_32x32x16_bf16 v[72:87], v[96:99], v[144:147], 0
    s_setprio 3
    ds_read_b128 v[112:115], v32
    ds_read_b128 v[116:119], v32 offset:1024
    s_add_u32 m0, s65, 122880
    s_add_u32 s73, s73, 8192
    buffer_load_dwordx4 v1, s[40:43], s73 offen sc1 lds
    v_exp_f32 v56, v56
    v_exp_f32 v57, v57
    v_exp_f32 v58, v58
    v_mfma_f32_32x32x16_bf16 v[12:27], v[124:127], v[92:95], v[12:27]
    ds_read_b128 v[120:123], v32 offset:2048
    s_add_u32 m0, s65, 131072
    s_add_u32 s73, s73, 8192
    buffer_load_dwordx4 v1, s[40:43], s73 offen sc1 lds
    v_exp_f32 v59, v59
    v_cvt_pk_bf16_f32 v88, v56, v57
    v_exp_f32 v60, v60
    v_exp_f32 v61, v61
    v_mfma_f32_32x32x16_bf16 v[72:87], v[100:103], v[148:151], v[72:87]
    ds_read_b128 v[124:127], v32 offset:3072
    s_add_u32 m0, s65, 139264
    s_add_u32 s73, s73, 8192
    buffer_load_dwordx4 v1, s[40:43], s73 offen sc1 lds
    v_cvt_pk_bf16_f32 v89, v58, v59
    v_exp_f32 v62, v62
    v_exp_f32 v63, v63
    v_cvt_pk_bf16_f32 v90, v60, v61
    v_cvt_pk_bf16_f32 v91, v62, v63
    s_nop 0
    s_nop 0
    v_mfma_f32_32x32x16_bf16 v[12:27], v[136:139], v[88:91], v[12:27]
    s_waitcnt lgkmcnt(0)
    v_exp_f32 v64, v64
    v_exp_f32 v65, v65
    v_exp_f32 v66, v66
    v_exp_f32 v67, v67
    v_cvt_pk_bf16_f32 v92, v64, v65
    v_exp_f32 v68, v68
    v_exp_f32 v69, v69
    v_cvt_pk_bf16_f32 v93, v66, v67
    v_exp_f32 v70, v70
    v_exp_f32 v71, v71
    v_cvt_pk_bf16_f32 v94, v68, v69
    v_cvt_pk_bf16_f32 v95, v70, v71
    v_mfma_f32_32x32x16_bf16 v[56:71], v[112:115], v[144:147], 0
    s_setprio 2
    ds_read_b128 v[128:131], v32 offset:8192
    ds_read_b128 v[132:135], v32 offset:9216
    s_add_u32 m0, s65, 147456
    s_add_u32 s73, s73, 8192
    buffer_load_dwordx4 v1, s[40:43], s73 offen sc1 lds
    v_exp_f32 v72, v72
    v_exp_f32 v73, v73
    v_exp_f32 v74, v74
    v_mfma_f32_32x32x16_bf16 v[12:27], v[140:143], v[92:95], v[12:27]
    ds_read_b128 v[136:139], v32 offset:10240
    s_cmp_eq_u32 s62, 0
    s_cbranch_scc0 L_G25
    buffer_load_dword v253, v41, s[40:43], s10 offen sc1
L_G25:
    buffer_store_dwordx4 v[208:211], v1, s[40:43], s80 offen sc1
    v_exp_f32 v75, v75
    v_cvt_pk_bf16_f32 v88, v72, v73
    v_exp_f32 v76, v76
    v_exp_f32 v77, v77
    v_mfma_f32_32x32x16_bf16 v[56:71], v[116:119], v[148:151], v[56:71]
    ds_read_b128 v[140:143], v32 offset:11264
    buffer_store_dwordx4 v[216:219], v1, s[40:43], s80 offen offset:1024 sc1
    v_cvt_pk_bf16_f32 v89, v74, v75
    v_exp_f32 v78, v78
    v_exp_f32 v79, v79
    v_cvt_pk_bf16_f32 v90, v76, v77
    v_cvt_pk_bf16_f32 v91, v78, v79
    s_nop 0
    s_nop 0
    v_mfma_f32_32x32x16_bf16 v[12:27], v[104:107], v[88:91], v[12:27]
    s_waitcnt lgkmcnt(0)
    v_exp_f32 v80, v80
    v_exp_f32 v81, v81
    v_exp_f32 v82, v82
    v_exp_f32 v83, v83
    v_cvt_pk_bf16_f32 v92, v80, v81
    v_exp_f32 v84, v84
    v_exp_f32 v85, v85
    v_cvt_pk_bf16_f32 v93, v82, v83
    v_exp_f32 v86, v86
    v_exp_f32 v87, v87
    v_cvt_pk_bf16_f32 v94, v84, v85
    v_cvt_pk_bf16_f32 v95, v86, v87
    v_mfma_f32_32x32x16_bf16 v[72:87], v[128:131], v[144:147], 0
    s_setprio 1
    ds_read_b128 v[96:99], v32 offset:16384
    ds_read_b128 v[100:103], v32 offset:17408
    v_exp_f32 v56, v56
    v_exp_f32 v57, v57
    v_exp_f32 v58, v58
    v_mfma_f32_32x32x16_bf16 v[12:27], v[108:111], v[92:95], v[12:27]
    ds_read_b128 v[104:107], v32 offset:18432
    v_exp_f32 v59, v59
    v_cvt_pk_bf16_f32 v88, v56, v57
    v_exp_f32 v60, v60
    v_exp_f32 v61, v61
    v_mfma_f32_32x32x16_bf16 v[72:87], v[132:135], v[148:151], v[72:87]
    ds_read_b128 v[108:111], v32 offset:19456
    v_cvt_pk_bf16_f32 v89, v58, v59
    v_exp_f32 v62, v62
    v_exp_f32 v63, v63
    v_cvt_pk_bf16_f32 v90, v60, v61
    v_cvt_pk_bf16_f32 v91, v62, v63
    s_nop 0
    s_nop 0
    v_mfma_f32_32x32x16_bf16 v[12:27], v[120:123], v[88:91], v[12:27]
    s_waitcnt lgkmcnt(0)
    v_exp_f32 v64, v64
    v_exp_f32 v65, v65
    v_exp_f32 v66, v66
    v_exp_f32 v67, v67
    v_cvt_pk_bf16_f32 v92, v64, v65
    v_exp_f32 v68, v68
    v_exp_f32 v69, v69
    v_cvt_pk_bf16_f32 v93, v66, v67
    v_exp_f32 v70, v70
    v_exp_f32 v71, v71
    v_cvt_pk_bf16_f32 v94, v68, v69
    v_cvt_pk_bf16_f32 v95, v70, v71
    v_mfma_f32_32x32x16_bf16 v[56:71], v[96:99], v[144:147], 0
    s_setprio 0
    ds_read_b128 v[112:115], v32 offset:24576
    ds_read_b128 v[116:119], v32 offset:25600
    v_exp_f32 v72, v72
    v_exp_f32 v73, v73
    v_exp_f32 v74, v74
    v_mfma_f32_32x32x16_bf16 v[12:27], v[124:127], v[92:95], v[12:27]
    ds_read_b128 v[120:123], v32 offset:26624
    v_exp_f32 v75, v75
    v_cvt_pk_bf16_f32 v88, v72, v73
    v_exp_f32 v76, v76
    v_exp_f32 v77, v77
    v_mfma_f32_32x32x16_bf16 v[56:71], v[100:103], v[148:151], v[56:71]
    ds_read_b128 v[124:127], v32 offset:27648
    v_cvt_pk_bf16_f32 v89, v74, v75
    v_exp_f32 v78, v78
    v_exp_f32 v79, v79
    v_cvt_pk_bf16_f32 v90, v76, v77
    v_cvt_pk_bf16_f32 v91, v78, v79
    s_nop 0
    s_nop 0
    v_mfma_f32_32x32x16_bf16 v[12:27], v[136:139], v[88:91], v[12:27]
    s_waitcnt lgkmcnt(0)
    v_exp_f32 v80, v80
    v_exp_f32 v81, v81
    v_exp_f32 v82, v82
    v_exp_f32 v83, v83
    v_cvt_pk_bf16_f32 v92, v80, v81
    v_exp_f32 v84, v84
    v_exp_f32 v85, v85
    v_cvt_pk_bf16_f32 v93, v82, v83
    v_exp_f32 v86, v86
    v_exp_f32 v87, v87
    v_cvt_pk_bf16_f32 v94, v84, v85
    v_cvt_pk_bf16_f32 v95, v86, v87
    s_waitcnt vmcnt(9)
    s_cmp_lg_u32 s62, 0
    s_cbranch_scc1 L_OK26
    s_waitcnt vmcnt(2)
    s_mov_b32 s90, 100000
L_SP26:
    v_and_b32 v253, 0xff, v253
    v_cmp_ne_u32 vcc, 1, v253
    s_nop 1
    s_cbranch_vccz L_OK26
    s_sleep 4
    buffer_load_dword v253, v41, s[40:43], s10 offen sc1
    s_sub_u32 s90, s90, 1
    s_waitcnt vmcnt(0)
    s_cbranch_scc0 L_SP26
L_OK26:
    s_barrier
    v_mfma_f32_32x32x16_bf16 v[72:87], v[112:115], v[144:147], 0
    s_setprio 3
    ds_read_b128 v[128:131], v32 offset:40960
    ds_read_b128 v[132:135], v32 offset:41984
    buffer_load_dwordx4 v[192:195], v1, s[40:43], s75 offen sc1
    buffer_load_dwordx4 v[196:199], v1, s[40:43], s75 offen offset:1024 sc1
    v_exp_f32 v56, v56
    v_exp_f32 v57, v57
    v_exp_f32 v58, v58
    v_mfma_f32_32x32x16_bf16 v[12:27], v[140:143], v[92:95], v[12:27]
    ds_read_b128 v[136:139], v32 offset:43008
    s_add_u32 m0, s65, 0
    s_add_u32 s73, s73, 8192
    buffer_load_dwordx4 v6, s[44:47], s74 offen lds
    v_exp_f32 v59, v59
    v_cvt_pk_bf16_f32 v88, v56, v57
    v_exp_f32 v60, v60
    v_exp_f32 v61, v61
    v_mfma_f32_32x32x16_bf16 v[72:87], v[116:119], v[148:151], v[72:87]
    ds_read_b128 v[140:143], v32 offset:44032
    s_add_u32 m0, s65, 8192
    s_add_u32 s74, s74, 14336
    buffer_load_dwordx4 v1, s[40:43], s73 offen sc1 lds
    v_cvt_pk_bf16_f32 v89, v58, v59
    v_exp_f32 v62, v62
    v_exp_f32 v63, v63
    v_cvt_pk_bf16_f32 v90, v60, v61
    v_cvt_pk_bf16_f32 v91, v62, v63
    s_nop 0
    s_nop 0
    v_mfma_f32_32x32x16_bf16 v[12:27], v[104:107], v[88:91], v[12:27]
    s_waitcnt lgkmcnt(0)
    v_exp_f32 v64, v64
    v_exp_f32 v65, v65
    v_exp_f32 v66, v66
    v_exp_f32 v67, v67
    v_cvt_pk_bf16_f32 v92, v64, v65
    v_exp_f32 v68, v68
    v_exp_f32 v69, v69
    v_cvt_pk_bf16_f32 v93, v66, v67
    v_exp_f32 v70, v70
    v_exp_f32 v71, v71
    v_cvt_pk_bf16_f32 v94, v68, v69
    v_cvt_pk_bf16_f32 v95, v70, v71
    v_mfma_f32_32x32x16_bf16 v[56:71], v[128:131], v[144:147], 0
    s_setprio 2
    ds_read_b128 v[96:99], v32 offset:49152
    ds_read_b128 v[100:103], v32 offset:50176
    buffer_load_dwordx4 v[200:203], v1, s[40:43], s75 offen offset:2048 sc1
    buffer_load_dwordx4 v[204:207], v1, s[40:43], s75 offen offset:3072 sc1
    s_add_u32 s75, s75, 4096
    v_exp_f32 v72, v72
    v_exp_f32 v73, v73
    v_exp_f32 v74, v74
    v_mfma_f32_32x32x16_bf16 v[12:27], v[108:111], v[92:95], v[12:27]
    ds_read_b128 v[104:107], v32 offset:51200
    s_add_u32 m0, s65, 16384
    s_add_u32 s73, s73, 8192
    buffer_load_dwordx4 v6, s[44:47], s74 offen lds
    v_exp_f32 v75, v75
    v_cvt_pk_bf16_f32 v88, v72, v73
    v_exp_f32 v76, v76
    v_exp_f32 v77, v77
    v_mfma_f32_32x32x16_bf16 v[56:71], v[132:135], v[148:151], v[56:71]
    ds_read_b128 v[108:111], v32 offset:52224
    s_add_u32 m0, s65, 24576
    s_add_u32 s74, s74, 14336
    buffer_load_dwordx4 v1, s[40:43], s73 offen sc1 lds
    v_cvt_pk_bf16_f32 v89, v74, v75
    v_exp_f32 v78, v78
    v_exp_f32 v79, v79
    v_cvt_pk_bf16_f32 v90, v76, v77
    v_cvt_pk_bf16_f32 v91, v78, v79
    s_nop 0
    s_nop 0
    v_mfma_f32_32x32x16_bf16 v[12:27], v[120:123], v[88:91], v[12:27]
    s_waitcnt lgkmcnt(0)
    v_exp_f32 v80, v80
    v_exp_f32 v81, v81
    v_exp_f32 v82, v82
    v_exp_f32 v83, v83
    v_cvt_pk_bf16_f32 v92, v80, v81
    v_exp_f32 v84, v84
    v_exp_f32 v85, v85
    v_cvt_pk_bf16_f32 v93, v82, v83
    v_exp_f32 v86, v86
    v_exp_f32 v87, v87
    v_cvt_pk_bf16_f32 v94, v84, v85
    v_cvt_pk_bf16_f32 v95, v86, v87
    v_mfma_f32_32x32x16_bf16 v[72:87], v[96:99], v[144:147], 0
    s_setprio 1
    ds_read_b128 v[112:115], v32 offset:57344
    ds_read_b128 v[116:119], v32 offset:58368
    buffer_load_dwordx4 v[208:211], v1, s[40:43], s75 offen sc1
    v_exp_f32 v56, v56
    v_exp_f32 v57, v57
    v_exp_f32 v58, v58
    v_mfma_f32_32x32x16_bf16 v[12:27], v[124:127], v[92:95], v[12:27]
    ds_read_b128 v[120:123], v32 offset:59392
    v_exp_f32 v59, v59
    v_cvt_pk_bf16_f32 v88, v56, v57
    v_exp_f32 v60, v60
    v_exp_f32 v61, v61
    v_mfma_f32_32x32x16_bf16 v[72:87], v[100:103], v[148:151], v[72:87]
    ds_read_b128 v[124:127], v32 offset:60416
    v_cvt_pk_bf16_f32 v89, v58, v59
    v_exp_f32 v62, v62
    v_exp_f32 v63, v63
    v_cvt_pk_bf16_f32 v90, v60, v61
    v_cvt_pk_bf16_f32 v91, v62, v63
    s_nop 0
    s_nop 0
    v_mfma_f32_32x32x16_bf16 v[12:27], v[136:139], v[88:91], v[12:27]
    s_waitcnt lgkmcnt(0)
    v_exp_f32 v64, v64
    v_exp_f32 v65, v65
    v_exp_f32 v66, v66
    v_exp_f32 v67, v67
    v_cvt_pk_bf16_f32 v92, v64, v65
    v_exp_f32 v68, v68
    v_exp_f32 v69, v69
    v_cvt_pk_bf16_f32 v93, v66, v67
    v_exp_f32 v70, v70
    v_exp_f32 v71, v71
    v_cvt_pk_bf16_f32 v94, v68, v69
    v_cvt_pk_bf16_f32 v95, v70, v71
    s_waitcnt vmcnt(9)
    s_barrier
    s_cmp_eq_u32 s62, 0
    s_cbranch_scc0 L_G27
    buffer_store_dword v248, v7, s[40:43], s85 offen sc1
L_G27:
    v_mfma_f32_32x32x16_bf16 v[56:71], v[112:115], v[144:147], 0
    s_setprio 3
    ds_read_b128 v[128:131], v33
    ds_read_b128 v[132:135], v33 offset:1024
    buffer_load_dwordx4 v[212:215], v1, s[40:43], s75 offen offset:1024 sc1
    v_exp_f32 v72, v72
    v_exp_f32 v73, v73
    v_exp_f32 v74, v74
    v_mfma_f32_32x32x16_bf16 v[12:27], v[140:143], v[92:95], v[12:27]
    ds_read_b128 v[136:139], v33 offset:2048
    s_add_u32 m0, s65, 40960
    s_add_u32 s73, s73, 8192
    buffer_load_dwordx4 v6, s[44:47], s74 offen lds
    v_exp_f32 v75, v75
    v_cvt_pk_bf16_f32 v88, v72, v73
    v_exp_f32 v76, v76
    v_exp_f32 v77, v77
    v_mfma_f32_32x32x16_bf16 v[56:71], v[116:119], v[148:151], v[56:71]
    ds_read_b128 v[140:143], v33 offset:3072
    s_add_u32 m0, s65, 49152
    s_add_u32 s74, s74, 14336
    buffer_load_dwordx4 v1, s[40:43], s73 offen sc1 lds
    v_cvt_pk_bf16_f32 v89, v74, v75
    v_exp_f32 v78, v78
    v_exp_f32 v79, v79
    v_cvt_pk_bf16_f32 v90, v76, v77
    v_cvt_pk_bf16_f32 v91, v78, v79
    s_nop 0
    s_nop 0
    v_mfma_f32_32x32x16_bf16 v[12:27], v[104:107], v[88:91], v[12:27]
    s_waitcnt lgkmcnt(0)
    v_exp_f32 v80, v80
    v_exp_f32 v81, v81
    v_exp_f32 v82, v82
    v_exp_f32 v83, v83
    v_cvt_pk_bf16_f32 v92, v80, v81
    v_exp_f32 v84, v84
    v_exp_f32 v85, v85
    v_cvt_pk_bf16_f32 v93, v82, v83
    v_exp_f32 v86, v86
    v_exp_f32 v87, v87
    v_cvt_pk_bf16_f32 v94, v84, v85
    v_cvt_pk_bf16_f32 v95, v86, v87
    v_mfma_f32_32x32x16_bf16 v[72:87], v[128:131], v[144:147], 0
    s_setprio 2
    ds_read_b128 v[96:99], v33 offset:16384
    ds_read_b128 v[100:103], v33 offset:17408
    buffer_load_dwordx4 v[216:219], v1, s[40:43], s75 offen offset:2048 sc1
    v_exp_f32 v56, v56
    v_exp_f32 v57, v57
    v_exp_f32 v58, v58
    v_mfma_f32_32x32x16_bf16 v[12:27], v[108:111], v[92:95], v[12:27]
    ds_read_b128 v[104:107], v33 offset:18432
    ds_read_b64_tr_b16 v[224:225], v35 offset:32768
    ds_read_b64_tr_b16 v[226:227], v35 offset:33792
    s_add_u32 m0, s65, 57344
    s_add_u32 s73, s73, 8192
    buffer_load_dwordx4 v6, s[44:47], s74 offen lds
    v_exp_f32 v59, v59
    v_cvt_pk_bf16_f32 v88, v56, v57
    v_exp_f32 v60, v60
    v_exp_f32 v61, v61
    v_mfma_f32_32x32x16_bf16 v[72:87], v[132:135], v[148:151], v[72:87]
    ds_read_b128 v[108:111], v33 offset:19456
    ds_read_b64_tr_b16 v[228:229], v38 offset:32768
    ds_read_b64_tr_b16 v[230:231], v38 offset:33792
    v_cvt_pk_bf16_f32 v89, v58, v59
    v_exp_f32 v62, v62
    v_exp_f32 v63, v63
    v_cvt_pk_bf16_f32 v90, v60, v61
    v_cvt_pk_bf16_f32 v91, v62, v63
    s_nop 0
    s_nop 0
    v_mfma_f32_32x32x16_bf16 v[12:27], v[120:123], v[88:91], v[12:27]
    s_waitcnt lgkmcnt(0)
    s_waitcnt vmcnt(13)
    v_exp_f32 v64, v64
    v_exp_f32 v65, v65
    v_exp_f32 v66, v66
    v_exp_f32 v67, v67
    v_cvt_pk_bf16_f32 v92, v64, v65
    v_exp_f32 v68, v68
    v_exp_f32 v69, v69
    v_cvt_pk_bf16_f32 v93, v66, v67
    v_exp_f32 v70, v70
    v_exp_f32 v71, v71
    v_cvt_pk_bf16_f32 v94, v68, v69
    v_cvt_pk_bf16_f32 v95, v70, v71
    v_mfma_f32_32x32x16_bf16 v[56:71], v[96:99], v[144:147], 0
    s_setprio 1
    ds_read_b128 v[112:115], v33 offset:24576
    ds_read_b128 v[116:119], v33 offset:25600
    buffer_load_dwordx4 v[220:223], v1, s[40:43], s75 offen offset:3072 sc1
    s_add_u32 s75, s75, 4096
    v_exp_f32 v72, v72
    v_exp_f32 v73, v73
    v_exp_f32 v74, v74
    v_mfma_f32_32x32x16_bf16 v[12:27], v[124:127], v[92:95], v[12:27]
    ds_read_b128 v[120:123], v33 offset:26624
    ds_read_b64_tr_b16 v[232:233], v36 offset:8192
    ds_read_b64_tr_b16 v[234:235], v36 offset:9216
    v_exp_f32 v75, v75
    v_cvt_pk_bf16_f32 v88, v72, v73
    v_exp_f32 v76, v76
    v_exp_f32 v77, v77
    v_mfma_f32_32x32x16_bf16 v[56:71], v[100:103], v[148:151], v[56:71]
    ds_read_b128 v[124:127], v33 offset:27648
    ds_read_b64_tr_b16 v[236:237], v39 offset:8192
    ds_read_b64_tr_b16 v[238:239], v39 offset:9216
    v_cvt_pk_bf16_f32 v89, v74, v75
    v_exp_f32 v78, v78
    v_exp_f32 v79, v79
    v_cvt_pk_bf16_f32 v90, v76, v77
    v_cvt_pk_bf16_f32 v91, v78, v79
    v_mfma_f32_32x32x16_bf16 v[160:175], v[224:227], v[192:195], 0
    v_exp_f32 v80, v80
    v_exp_f32 v81, v81
    v_exp_f32 v82, v82
    v_mfma_f32_32x32x16_bf16 v[12:27], v[136:139], v[88:91], v[12:27]
    v_exp_f32 v83, v83
    v_cvt_pk_bf16_f32 v92, v80, v81
    v_exp_f32 v84, v84
    v_exp_f32 v85, v85
    v_mfma_f32_32x32x16_bf16 v[176:191], v[228:231], v[192:195], 0
    s_waitcnt lgkmcnt(0)
    s_waitcnt vmcnt(13)
    v_cvt_pk_bf16_f32 v93, v82, v83
    v_exp_f32 v86, v86
    v_exp_f32 v87, v87
    v_cvt_pk_bf16_f32 v94, v84, v85
    v_cvt_pk_bf16_f32 v95, v86, v87
    s_barrier
    v_mfma_f32_32x32x16_bf16 v[72:87], v[112:115], v[144:147], 0
    s_setprio 3
    ds_read_b128 v[128:131], v33 offset:57344
    ds_read_b128 v[132:135], v33 offset:58368
    buffer_load_dwordx4 v[192:195], v1, s[40:43], s75 offen sc1
    s_add_u32 m0, s65, 65536
    s_add_u32 s74, s74, 14336
    buffer_load_dwordx4 v1, s[40:43], s73 offen sc1 lds
    v_exp_f32 v56, v56
    v_exp_f32 v57, v57
    v_exp_f32 v58, v58
    v_mfma_f32_32x32x16_bf16 v[12:27], v[140:143], v[92:95], v[12:27]
    ds_read_b128 v[136:139], v33 offset:59392
    ds_read_b64_tr_b16 v[224:225], v36 offset:32768
    ds_read_b64_tr_b16 v[226:227], v36 offset:33792
    s_add_u32 m0, s65, 32768
    s_add_u32 s73, s73, 8192
    buffer_load_dwordx4 v6, s[44:47], s74 offen lds
    v_exp_f32 v59, v59
    v_cvt_pk_bf16_f32 v88, v56, v57
    v_exp_f32 v60, v60
    v_exp_f32 v61, v61
    v_mfma_f32_32x32x16_bf16 v[72:87], v[116:119], v[148:151], v[72:87]
    ds_read_b128 v[140:143], v33 offset:60416
    ds_read_b64_tr_b16 v[228:229], v39 offset:32768
    ds_read_b64_tr_b16 v[230:231], v39 offset:33792
    s_cmp_eq_u32 s62, 0
    s_cbranch_scc0 L_G28
    buffer_load_dword v253, v42, s[40:43], s10 offen sc1
L_G28:
    v_cvt_pk_bf16_f32 v89, v58, v59
    v_exp_f32 v62, v62
    v_exp_f32 v63, v63
    v_cvt_pk_bf16_f32 v90, v60, v61
    v_cvt_pk_bf16_f32 v91, v62, v63
    v_mfma_f32_32x32x16_bf16 v[160:175], v[232:235], v[196:199], v[160:175]
    v_exp_f32 v64, v64
    v_exp_f32 v65, v65
    v_exp_f32 v66, v66
    v_mfma_f32_32x32x16_bf16 v[12:27], v[104:107], v[88:91], v[12:27]
    v_exp_f32 v67, v67
    v_cvt_pk_bf16_f32 v92, v64, v65
    v_exp_f32 v68, v68
    v_exp_f32 v69, v69
    v_mfma_f32_32x32x16_bf16 v[176:191], v[236:239], v[196:199], v[176:191]
    s_waitcnt lgkmcnt(0)
    s_waitcnt vmcnt(13)
    v_cvt_pk_bf16_f32 v93, v66, v67
    v_exp_f32 v70, v70
    v_exp_f32 v71, v71
    v_cvt_pk_bf16_f32 v94, v68, v69
    v_cvt_pk_bf16_f32 v95, v70, v71
    v_mfma_f32_32x32x16_bf16 v[56:71], v[128:131], v[144:147], 0
    s_setprio 2
    ds_read_b128 v[96:99], v34
    ds_read_b128 v[100:103], v34 offset:1024
    buffer_load_dwordx4 v[196:199], v1, s[40:43], s75 offen offset:1024 sc1
    v_exp_f32 v72, v72
    v_exp_f32 v73, v73
    v_exp_f32 v74, v74
    v_mfma_f32_32x32x16_bf16 v[12:27], v[108:111], v[92:95], v[12:27]
    ds_read_b128 v[104:107], v34 offset:2048
    ds_read_b64_tr_b16 v[232:233], v36 offset:40960
    ds_read_b64_tr_b16 v[234:235], v36 offset:41984
    s_add_u32 m0, s65, 81920
    s_add_u32 s74, s74, 14336
    buffer_load_dwordx4 v1, s[40:43], s73 offen sc1 lds
    v_exp_f32 v75, v75
    v_cvt_pk_bf16_f32 v88, v72, v73
    v_exp_f32 v76, v76
    v_exp_f32 v77, v77
    v_mfma_f32_32x32x16_bf16 v[56:71], v[132:135], v[148:151], v[56:71]
    ds_read_b128 v[108:111], v34 offset:3072
    ds_read_b64_tr_b16 v[236:237], v39 offset:40960
    ds_read_b64_tr_b16 v[238:239], v39 offset:41984
    s_add_u32 m0, s65, 73728
    s_add_u32 s73, s73, 8192
    buffer_load_dwordx4 v6, s[44:47], s74 offen lds
    v_cvt_pk_bf16_f32 v89, v74, v75
    v_exp_f32 v78, v78
    v_exp_f32 v79, v79
    v_cvt_pk_bf16_f32 v90, v76, v77
    v_cvt_pk_bf16_f32 v91, v78, v79
    v_mfma_f32_32x32x16_bf16 v[160:175], v[224:227], v[200:203], v[160:175]
    v_exp_f32 v80, v80
    v_exp_f32 v81, v81
    v_exp_f32 v82, v82
    v_mfma_f32_32x32x16_bf16 v[12:27], v[120:123], v[88:91], v[12:27]
    v_exp_f32 v83, v83
    v_cvt_pk_bf16_f32 v92, v80, v81
    v_exp_f32 v84, v84
    v_exp_f32 v85, v85
    v_mfma_f32_32x32x16_bf16 v[176:191], v[228:231], v[200:203], v[176:191]
    s_waitcnt lgkmcnt(0)
    s_waitcnt vmcnt(15)
    v_cvt_pk_bf16_f32 v93, v82, v83
    v_exp_f32 v86, v86
    v_exp_f32 v87, v87
    v_cvt_pk_bf16_f32 v94, v84, v85
    v_cvt_pk_bf16_f32 v95, v86, v87
    v_mfma_f32_32x32x16_bf16 v[72:87], v[96:99], v[144:147], 0
    s_setprio 1
    ds_read_b128 v[112:115], v34 offset:8192
    ds_read_b128 v[116:119], v34 offset:9216
    buffer_load_dwordx4 v[200:203], v1, s[40:43], s75 offen offset:2048 sc1
    v_exp_f32 v56, v56
    v_exp_f32 v57, v57
    v_exp_f32 v58, v58
    v_mfma_f32_32x32x16_bf16 v[12:27], v[124:127], v[92:95], v[12:27]
    ds_read_b128 v[120:123], v34 offset:10240
    ds_read_b64_tr_b16 v[224:225], v36 offset:49152
    ds_read_b64_tr_b16 v[226:227], v36 offset:50176
    s_add_u32 m0, s65, 90112
    s_add_u32 s74, s74, 14336
    buffer_load_dwordx4 v1, s[40:43], s73 offen sc1 lds
    v_exp_f32 v59, v59
    v_cvt_pk_bf16_f32 v88, v56, v57
    v_exp_f32 v60, v60
    v_exp_f32 v61, v61
    v_mfma_f32_32x32x16_bf16 v[72:87], v[100:103], v[148:151], v[72:87]
    ds_read_b128 v[124:127], v34 offset:11264
    ds_read_b64_tr_b16 v[228:229], v39 offset:49152
    ds_read_b64_tr_b16 v[230:231], v39 offset:50176
    v_cvt_pk_bf16_f32 v89, v58, v59
    v_exp_f32 v62, v62
    v_exp_f32 v63, v63
    v_cvt_pk_bf16_f32 v90, v60, v61
    v_cvt_pk_bf16_f32 v91, v62, v63
    v_mfma_f32_32x32x16_bf16 v[160:175], v[232:235], v[204:207], v[160:175]
    v_exp_f32 v64, v64
    v_exp_f32 v65, v65
    v_exp_f32 v66, v66
    v_mfma_f32_32x32x16_bf16 v[12:27], v[136:139], v[88:91], v[12:27]
    v_exp_f32 v67, v67
    v_cvt_pk_bf16_f32 v92, v64, v65
    v_exp_f32 v68, v68
    v_exp_f32 v69, v69
    v_mfma_f32_32x32x16_bf16 v[176:191], v[236:239], v[204:207], v[176:191]
    s_waitcnt lgkmcnt(0)
    s_waitcnt vmcnt(14)
    v_cvt_pk_bf16_f32 v93, v66, v67
    v_exp_f32 v70, v70
    v_exp_f32 v71, v71
    v_cvt_pk_bf16_f32 v94, v68, v69
    v_cvt_pk_bf16_f32 v95, v70, v71
    s_waitcnt vmcnt(12)
    s_cmp_lg_u32 s62, 0
    s_cbranch_scc1 L_OK29
    s_waitcnt vmcnt(5)
    s_mov_b32 s90, 100000
L_SP29:
    v_and_b32 v253, 0xff, v253
    v_cmp_ne_u32 vcc, 1, v253
    s_nop 1
    s_cbranch_vccz L_OK29
    s_sleep 4
    buffer_load_dword v253, v42, s[40:43], s10 offen sc1
    s_sub_u32 s90, s90, 1
    s_waitcnt vmcnt(0)
    s_cbranch_scc0 L_SP29
L_OK29:
    s_barrier
    v_mfma_f32_32x32x16_bf16 v[56:71], v[112:115], v[144:147], 0
    s_setprio 3
    ds_read_b128 v[128:131], v34 offset:16384
    ds_read_b128 v[132:135], v34 offset:17408
    buffer_load_dwordx4 v[204:207], v1, s[40:43], s75 offen offset:3072 sc1
    s_lshl_b32 s86, s78, 12
    s_add_u32 s75, s75, s86
    s_add_u32 s75, s75, 40960
    v_exp_f32 v72, v72
    v_exp_f32 v73, v73
    v_exp_f32 v74, v74
    v_mfma_f32_32x32x16_bf16 v[12:27], v[140:143], v[92:95], v[12:27]
    ds_read_b128 v[136:139], v34 offset:18432
    ds_read_b64_tr_b16 v[232:233], v35
    ds_read_b64_tr_b16 v[234:235], v35 offset:1024
    s_add_u32 m0, s65, 98304
    s_add_u32 s73, s73, 8192
    buffer_load_dwordx4 v6, s[44:47], s74 offen lds
    v_exp_f32 v75, v75
    v_cvt_pk_bf16_f32 v88, v72, v73
    v_exp_f32 v76, v76
    v_exp_f32 v77, v77
    v_mfma_f32_32x32x16_bf16 v[56:71], v[116:119], v[148:151], v[56:71]
    ds_read_b128 v[140:143], v34 offset:19456
    ds_read_b64_tr_b16 v[236:237], v38
    ds_read_b64_tr_b16 v[238:239], v38 offset:1024
    s_add_u32 m0, s65, 122880
    s_mul_i32 s86, s78, 57344
    s_add_u32 s74, s74, s86
    s_add_u32 s74, s74, 530432
    buffer_load_dwordx4 v1, s[40:43], s73 offen sc1 lds
    v_cvt_pk_bf16_f32 v89, v74, v75
    v_exp_f32 v78, v78
    v_exp_f32 v79, v79
    v_cvt_pk_bf16_f32 v90, v76, v77
    v_cvt_pk_bf16_f32 v91, v78, v79
    v_mfma_f32_32x32x16_bf16 v[160:175], v[224:227], v[208:211], v[160:175]
    v_exp_f32 v80, v80
    v_exp_f32 v81, v81
    v_exp_f32 v82, v82
    v_mfma_f32_32x32x16_bf16 v[12:27], v[104:107], v[88:91], v[12:27]
    v_exp_f32 v83, v83
    v_cvt_pk_bf16_f32 v92, v80, v81
    v_exp_f32 v84, v84
    v_exp_f32 v85, v85
    v_mfma_f32_32x32x16_bf16 v[176:191], v[228:231], v[208:211], v[176:191]
    s_waitcnt lgkmcnt(0)
    v_cvt_pk_bf16_f32 v93, v82, v83
    v_exp_f32 v86, v86
    v_exp_f32 v87, v87
    v_cvt_pk_bf16_f32 v94, v84, v85
    v_cvt_pk_bf16_f32 v95, v86, v87
    v_mfma_f32_32x32x16_bf16 v[72:87], v[128:131], v[144:147], 0
    s_setprio 2
    ds_read_b128 v[96:99], v32 offset:8192
    ds_read_b128 v[100:103], v32 offset:9216
    buffer_load_dwordx4 v[208:211], v1, s[40:43], s75 offen sc1
    v_exp_f32 v56, v56
    v_exp_f32 v57, v57
    v_exp_f32 v58, v58
    v_mfma_f32_32x32x16_bf16 v[12:27], v[108:111], v[92:95], v[12:27]
    ds_read_b128 v[104:107], v32 offset:10240
    ds_read_b64_tr_b16 v[224:225], v35 offset:16384
    ds_read_b64_tr_b16 v[226:227], v35 offset:17408
    s_add_u32 m0, s65, 106496
    s_add_u32 s73, s73, 8192
    buffer_load_dwordx4 v6, s[44:47], s74 offen lds
    v_exp_f32 v59, v59
    v_cvt_pk_bf16_f32 v88, v56, v57
    v_exp_f32 v60, v60
    v_exp_f32 v61, v61
    v_mfma_f32_32x32x16_bf16 v[72:87], v[132:135], v[148:151], v[72:87]
    ds_read_b128 v[108:111], v32 offset:11264
    ds_read_b64_tr_b16 v[228:229], v38 offset:16384
    ds_read_b64_tr_b16 v[230:231], v38 offset:17408
    s_add_u32 m0, s65, 131072
    s_add_u32 s74, s74, 14336
    buffer_load_dwordx4 v1, s[40:43], s73 offen sc1 lds
    v_cvt_pk_bf16_f32 v89, v58, v59
    v_exp_f32 v62, v62
    v_exp_f32 v63, v63
    v_cvt_pk_bf16_f32 v90, v60, v61
    v_cvt_pk_bf16_f32 v91, v62, v63
    v_mfma_f32_32x32x16_bf16 v[160:175], v[232:235], v[212:215], v[160:175]
    v_exp_f32 v64, v64
    v_exp_f32 v65, v65
    v_exp_f32 v66, v66
    v_mfma_f32_32x32x16_bf16 v[12:27], v[120:123], v[88:91], v[12:27]
    v_exp_f32 v67, v67
    v_cvt_pk_bf16_f32 v92, v64, v65
    v_exp_f32 v68, v68
    v_exp_f32 v69, v69
    v_mfma_f32_32x32x16_bf16 v[176:191], v[236:239], v[212:215], v[176:191]
    s_waitcnt lgkmcnt(0)
    s_waitcnt vmcnt(16)
    v_cvt_pk_bf16_f32 v93, v66, v67
    v_exp_f32 v70, v70
    v_exp_f32 v71, v71
    v_cvt_pk_bf16_f32 v94, v68, v69
    v_cvt_pk_bf16_f32 v95, v70, v71
    v_mfma_f32_32x32x16_bf16 v[56:71], v[96:99], v[144:147], 0
    s_setprio 1
    ds_read_b128 v[112:115], v32 offset:24576
    ds_read_b128 v[116:119], v32 offset:25600
    buffer_load_dwordx4 v[212:215], v1, s[40:43], s75 offen offset:1024 sc1
    v_exp_f32 v72, v72
    v_exp_f32 v73, v73
    v_exp_f32 v74, v74
    v_mfma_f32_32x32x16_bf16 v[12:27], v[124:127], v[92:95], v[12:27]
    ds_read_b128 v[120:123], v32 offset:26624
    ds_read_b64_tr_b16 v[232:233], v35 offset:40960
    ds_read_b64_tr_b16 v[234:235], v35 offset:41984
    s_add_u32 m0, s65, 114688
    s_add_u32 s73, s73, 8192
    buffer_load_dwordx4 v6, s[44:47], s74 offen lds
    v_exp_f32 v75, v75
    v_cvt_pk_bf16_f32 v88, v72, v73
    v_exp_f32 v76, v76
    v_exp_f32 v77, v77
    v_mfma_f32_32x32x16_bf16 v[56:71], v[100:103], v[148:151], v[56:71]
    ds_read_b128 v[124:127], v32 offset:27648
    ds_read_b64_tr_b16 v[236:237], v38 offset:40960
    ds_read_b64_tr_b16 v[238:239], v38 offset:41984
    s_add_u32 m0, s65, 139264
    s_add_u32 s74, s74, 14336
    buffer_load_dwordx4 v1, s[40:43], s73 offen sc1 lds
    v_cvt_pk_bf16_f32 v89, v74, v75
    v_exp_f32 v78, v78
    v_exp_f32 v79, v79
    v_cvt_pk_bf16_f32 v90, v76, v77
    v_cvt_pk_bf16_f32 v91, v78, v79
    v_mfma_f32_32x32x16_bf16 v[160:175], v[224:227], v[216:219], v[160:175]
    v_exp_f32 v80, v80
    v_exp_f32 v81, v81
    v_exp_f32 v82, v82
    v_mfma_f32_32x32x16_bf16 v[12:27], v[136:139], v[88:91], v[12:27]
    v_exp_f32 v83, v83
    v_cvt_pk_bf16_f32 v92, v80, v81
    v_exp_f32 v84, v84
    v_exp_f32 v85, v85
    v_mfma_f32_32x32x16_bf16 v[176:191], v[228:231], v[216:219], v[176:191]
    s_waitcnt lgkmcnt(0)
    s_waitcnt vmcnt(17)
    v_cvt_pk_bf16_f32 v93, v82, v83
    v_exp_f32 v86, v86
    v_exp_f32 v87, v87
    v_cvt_pk_bf16_f32 v94, v84, v85
    v_cvt_pk_bf16_f32 v95, v86, v87
    s_waitcnt vmcnt(11)
    s_barrier
    v_mfma_f32_32x32x16_bf16 v[72:87], v[112:115], v[144:147], 0
    s_setprio 3
    ds_read_b128 v[128:131], v32 offset:49152
    ds_read_b128 v[132:135], v32 offset:50176
    buffer_load_dwordx4 v[216:219], v1, s[40:43], s75 offen offset:2048 sc1
    v_exp_f32 v56, v56
    v_exp_f32 v57, v57
    v_exp_f32 v58, v58
    v_mfma_f32_32x32x16_bf16 v[12:27], v[140:143], v[92:95], v[12:27]
    ds_read_b128 v[136:139], v32 offset:51200
    ds_read_b64_tr_b16 v[224:225], v35 offset:57344
    ds_read_b64_tr_b16 v[226:227], v35 offset:58368
    s_add_u32 m0, s65, 147456
    s_add_u32 s73, s73, 8192
    buffer_load_dwordx4 v6, s[44:47], s74 offen lds
    v_exp_f32 v59, v59
    v_cvt_pk_bf16_f32 v88, v56, v57
    v_exp_f32 v60, v60
    v_exp_f32 v61, v61
    v_mfma_f32_32x32x16_bf16 v[72:87], v[116:119], v[148:151], v[72:87]
    ds_read_b128 v[140:143], v32 offset:52224
    ds_read_b64_tr_b16 v[228:229], v38 offset:57344
    ds_read_b64_tr_b16 v[230:231], v38 offset:58368
    s_add_u32 m0, s65, 0
    s_add_u32 s74, s74, 14336
    buffer_load_dwordx4 v1, s[40:43], s73 offen sc1 lds
    v_cvt_pk_bf16_f32 v89, v58, v59
    v_exp_f32 v62, v62
    v_exp_f32 v63, v63
    v_cvt_pk_bf16_f32 v90, v60, v61
    v_cvt_pk_bf16_f32 v91, v62, v63
    v_mfma_f32_32x32x16_bf16 v[160:175], v[232:235], v[220:223], v[160:175]
    v_exp_f32 v64, v64
    v_exp_f32 v65, v65
    v_exp_f32 v66, v66
    v_mfma_f32_32x32x16_bf16 v[12:27], v[104:107], v[88:91], v[12:27]
    v_exp_f32 v67, v67
    v_cvt_pk_bf16_f32 v92, v64, v65
    v_exp_f32 v68, v68
    v_exp_f32 v69, v69
    v_mfma_f32_32x32x16_bf16 v[176:191], v[236:239], v[220:223], v[176:191]
    s_waitcnt lgkmcnt(0)
    v_cvt_pk_bf16_f32 v93, v66, v67
    v_exp_f32 v70, v70
    v_exp_f32 v71, v71
    v_cvt_pk_bf16_f32 v94, v68, v69
    v_cvt_pk_bf16_f32 v95, v70, v71
    v_mfma_f32_32x32x16_bf16 v[56:71], v[128:131], v[144:147], 0
    s_setprio 2
    ds_read_b128 v[96:99], v33
    ds_read_b128 v[100:103], v33 offset:1024
    buffer_load_dwordx4 v[220:223], v1, s[40:43], s75 offen offset:3072 sc1
    s_add_u32 s75, s75, 4096
    v_exp_f32 v72, v72
    v_exp_f32 v73, v73
    v_exp_f32 v74, v74
    v_mfma_f32_32x32x16_bf16 v[12:27], v[108:111], v[92:95], v[12:27]
    ds_read_b128 v[104:107], v33 offset:2048
    ds_read_b64_tr_b16 v[232:233], v35 offset:32768
    ds_read_b64_tr_b16 v[234:235], v35 offset:33792
    s_add_u32 m0, s65, 8192
    s_add_u32 s73, s73, 8192
    buffer_load_dwordx4 v6, s[44:47], s74 offen lds
    v_exp_f32 v75, v75
    v_cvt_pk_bf16_f32 v88, v72, v73
    v_exp_f32 v76, v76
    v_exp_f32 v77, v77
    v_mfma_f32_32x32x16_bf16 v[56:71], v[132:135], v[148:151], v[56:71]
    ds_read_b128 v[108:111], v33 offset:3072
    ds_read_b64_tr_b16 v[236:237], v38 offset:32768
    ds_read_b64_tr_b16 v[238:239], v38 offset:33792
    s_add_u32 m0, s65, 16384
    s_add_u32 s74, s74, 14336
    buffer_load_dwordx4 v1, s[40:43], s73 offen sc1 lds
    v_cvt_pk_bf16_f32 v89, v74, v75
    v_exp_f32 v78, v78
    v_exp_f32 v79, v79
    v_cvt_pk_bf16_f32 v90, v76, v77
    v_cvt_pk_bf16_f32 v91, v78, v79
    v_mfma_f32_32x32x16_bf16 v[160:175], v[224:227], v[192:195], v[160:175]
    v_exp_f32 v80, v80
    v_exp_f32 v81, v81
    v_exp_f32 v82, v82
    v_mfma_f32_32x32x16_bf16 v[12:27], v[120:123], v[88:91], v[12:27]
    v_exp_f32 v83, v83
    v_cvt_pk_bf16_f32 v92, v80, v81
    v_exp_f32 v84, v84
    v_exp_f32 v85, v85
    v_mfma_f32_32x32x16_bf16 v[176:191], v[228:231], v[192:195], v[176:191]
    s_waitcnt lgkmcnt(0)
    v_cvt_pk_bf16_f32 v93, v82, v83
    v_exp_f32 v86, v86
    v_exp_f32 v87, v87
    v_cvt_pk_bf16_f32 v94, v84, v85
    v_cvt_pk_bf16_f32 v95, v86, v87
    v_mfma_f32_32x32x16_bf16 v[72:87], v[96:99], v[144:147], 0
    s_setprio 1
    ds_read_b128 v[112:115], v33 offset:16384
    ds_read_b128 v[116:119], v33 offset:17408
    buffer_load_dwordx4 v[192:195], v1, s[40:43], s75 offen sc1
    s_add_u32 m0, s65, 24576
    s_add_u32 s73, s73, 8192
    buffer_load_dwordx4 v6, s[44:47], s74 offen lds
    v_exp_f32 v56, v56
    v_exp_f32 v57, v57
    v_exp_f32 v58, v58
    v_mfma_f32_32x32x16_bf16 v[12:27], v[124:127], v[92:95], v[12:27]
    ds_read_b128 v[120:123], v33 offset:18432
    ds_read_b64_tr_b16 v[224:225], v36 offset:8192
    ds_read_b64_tr_b16 v[226:227], v36 offset:9216
    s_add_u32 m0, s65, 40960
    s_add_u32 s74, s74, 14336
    buffer_load_dwordx4 v1, s[40:43], s73 offen sc1 lds
    v_exp_f32 v59, v59
    v_cvt_pk_bf16_f32 v88, v56, v57
    v_exp_f32 v60, v60
    v_exp_f32 v61, v61
    v_mfma_f32_32x32x16_bf16 v[72:87], v[100:103], v[148:151], v[72:87]
    ds_read_b128 v[124:127], v33 offset:19456
    ds_read_b64_tr_b16 v[228:229], v39 offset:8192
    ds_read_b64_tr_b16 v[230:231], v39 offset:9216
    buffer_load_dwordx4 v[240:243], v43, s[24:27], s91 offen
    v_cvt_pk_bf16_f32 v89, v58, v59
    v_exp_f32 v62, v62
    v_exp_f32 v63, v63
    v_cvt_pk_bf16_f32 v90, v60, v61
    v_cvt_pk_bf16_f32 v91, v62, v63
    v_mfma_f32_32x32x16_bf16 v[160:175], v[232:235], v[196:199], v[160:175]
    v_exp_f32 v64, v64
    v_exp_f32 v65, v65
    v_exp_f32 v66, v66
    v_mfma_f32_32x32x16_bf16 v[12:27], v[136:139], v[88:91], v[12:27]
    v_exp_f32 v67, v67
    v_cvt_pk_bf16_f32 v92, v64, v65
    v_exp_f32 v68, v68
    v_exp_f32 v69, v69
    v_mfma_f32_32x32x16_bf16 v[176:191], v[236:239], v[196:199], v[176:191]
    s_waitcnt lgkmcnt(0)
    s_waitcnt vmcnt(20)
    v_cvt_pk_bf16_f32 v93, v66, v67
    v_exp_f32 v70, v70
    v_exp_f32 v71, v71
    v_cvt_pk_bf16_f32 v94, v68, v69
    v_cvt_pk_bf16_f32 v95, v70, v71
    s_waitcnt vmcnt(11)
    s_barrier
    v_mfma_f32_32x32x16_bf16 v[56:71], v[112:115], v[144:147], 0
    s_setprio 3
    ds_read_b128 v[128:131], v33 offset:24576
    ds_read_b128 v[132:135], v33 offset:25600
    buffer_load_dwordx4 v[196:199], v1, s[40:43], s75 offen offset:1024 sc1
    v_exp_f32 v72, v72
    v_exp_f32 v73, v73
    v_exp_f32 v74, v74
    v_mfma_f32_32x32x16_bf16 v[12:27], v[140:143], v[92:95], v[12:27]
    ds_read_b128 v[136:139], v33 offset:26624
    ds_read_b64_tr_b16 v[232:233], v36 offset:32768
    ds_read_b64_tr_b16 v[234:235], v36 offset:33792
    s_add_u32 m0, s65, 49152
    s_add_u32 s73, s73, 8192
    buffer_load_dwordx4 v6, s[44:47], s74 offen lds
    v_exp_f32 v75, v75
    v_cvt_pk_bf16_f32 v88, v72, v73
    v_exp_f32 v76, v76
    v_exp_f32 v77, v77
    v_mfma_f32_32x32x16_bf16 v[56:71], v[116:119], v[148:151], v[56:71]
    ds_read_b128 v[140:143], v33 offset:27648
    ds_read_b64_tr_b16 v[236:237], v39 offset:32768
    ds_read_b64_tr_b16 v[238:239], v39 offset:33792
    s_add_u32 m0, s65, 57344
    s_add_u32 s74, s74, 14336
    buffer_load_dwordx4 v1, s[40:43], s73 offen sc1 lds
    v_cvt_pk_bf16_f32 v89, v74, v75
    v_exp_f32 v78, v78
    v_exp_f32 v79, v79
    v_cvt_pk_bf16_f32 v90, v76, v77
    v_cvt_pk_bf16_f32 v91, v78, v79
    v_mfma_f32_32x32x16_bf16 v[160:175], v[224:227], v[200:203], v[160:175]
    v_exp_f32 v80, v80
    v_exp_f32 v81, v81
    v_exp_f32 v82, v82
    v_mfma_f32_32x32x16_bf16 v[12:27], v[104:107], v[88:91], v[12:27]
    v_exp_f32 v83, v83
    v_cvt_pk_bf16_f32 v92, v80, v81
    v_exp_f32 v84, v84
    v_exp_f32 v85, v85
    v_mfma_f32_32x32x16_bf16 v[176:191], v[228:231], v[200:203], v[176:191]
    s_waitcnt lgkmcnt(0)
    v_cvt_pk_bf16_f32 v93, v82, v83
    v_exp_f32 v86, v86
    v_exp_f32 v87, v87
    v_cvt_pk_bf16_f32 v94, v84, v85
    v_cvt_pk_bf16_f32 v95, v86, v87
    v_mfma_f32_32x32x16_bf16 v[72:87], v[128:131], v[144:147], 0
    s_setprio 2
    ds_read_b128 v[96:99], v33 offset:57344
    ds_read_b128 v[100:103], v33 offset:58368
    buffer_load_dwordx4 v[200:203], v1, s[40:43], s75 offen offset:2048 sc1
    v_exp_f32 v56, v56
    v_exp_f32 v57, v57
    v_exp_f32 v58, v58
    v_mfma_f32_32x32x16_bf16 v[12:27], v[108:111], v[92:95], v[12:27]
    ds_read_b128 v[104:107], v33 offset:59392
    ds_read_b64_tr_b16 v[224:225], v36 offset:40960
    ds_read_b64_tr_b16 v[226:227], v36 offset:41984
    s_add_u32 m0, s65, 65536
    s_add_u32 s73, s73, 8192
    buffer_load_dwordx4 v6, s[44:47], s74 offen lds
    v_exp_f32 v59, v59
    v_cvt_pk_bf16_f32 v88, v56, v57
    v_exp_f32 v60, v60
    v_exp_f32 v61, v61
    v_mfma_f32_32x32x16_bf16 v[72:87], v[132:135], v[148:151], v[72:87]
    ds_read_b128 v[108:111], v33 offset:60416
    ds_read_b64_tr_b16 v[228:229], v39 offset:40960
    ds_read_b64_tr_b16 v[230:231], v39 offset:41984
    s_add_u32 m0, s65, 32768
    s_add_u32 s74, s74, 14336
    buffer_load_dwordx4 v1, s[40:43], s73 offen sc1 lds
    v_cvt_pk_bf16_f32 v89, v58, v59
    v_exp_f32 v62, v62
    v_exp_f32 v63, v63
    v_cvt_pk_bf16_f32 v90, v60, v61
    v_cvt_pk_bf16_f32 v91, v62, v63
    v_mfma_f32_32x32x16_bf16 v[160:175], v[232:235], v[204:207], v[160:175]
    v_exp_f32 v64, v64
    v_exp_f32 v65, v65
    v_exp_f32 v66, v66
    v_mfma_f32_32x32x16_bf16 v[12:27], v[120:123], v[88:91], v[12:27]
    v_exp_f32 v67, v67
    v_cvt_pk_bf16_f32 v92, v64, v65
    v_exp_f32 v68, v68
    v_exp_f32 v69, v69
    v_mfma_f32_32x32x16_bf16 v[176:191], v[236:239], v[204:207], v[176:191]
    s_waitcnt lgkmcnt(0)
    v_cvt_pk_bf16_f32 v93, v66, v67
    v_exp_f32 v70, v70
    v_exp_f32 v71, v71
    v_cvt_pk_bf16_f32 v94, v68, v69
    v_cvt_pk_bf16_f32 v95, v70, v71
    v_mfma_f32_32x32x16_bf16 v[56:71], v[96:99], v[144:147], 0
    s_setprio 1
    ds_read_b128 v[112:115], v34
    ds_read_b128 v[116:119], v34 offset:1024
    buffer_load_dwordx4 v[204:207], v1, s[40:43], s75 offen offset:3072 sc1
    s_add_u32 s75, s75, 4096
    v_exp_f32 v72, v72
    v_exp_f32 v73, v73
    v_exp_f32 v74, v74
    v_mfma_f32_32x32x16_bf16 v[12:27], v[124:127], v[92:95], v[12:27]
    ds_read_b128 v[120:123], v34 offset:2048
    ds_read_b64_tr_b16 v[232:233], v36 offset:49152
    ds_read_b64_tr_b16 v[234:235], v36 offset:50176
    s_add_u32 m0, s65, 81920
    s_add_u32 s73, s73, 8192
    buffer_load_dwordx4 v6, s[44:47], s74 offen lds
    v_exp_f32 v75, v75
    v_cvt_pk_bf16_f32 v88, v72, v73
    v_exp_f32 v76, v76
    v_exp_f32 v77, v77
    v_mfma_f32_32x32x16_bf16 v[56:71], v[100:103], v[148:151], v[56:71]
    ds_read_b128 v[124:127], v34 offset:3072
    ds_read_b64_tr_b16 v[236:237], v39 offset:49152
    ds_read_b64_tr_b16 v[238:239], v39 offset:50176
    s_add_u32 m0, s65, 73728
    s_add_u32 s74, s74, 14336
    buffer_load_dwordx4 v6, s[44:47], s74 offen lds
    v_cvt_pk_bf16_f32 v89, v74, v75
    v_exp_f32 v78, v78
    v_exp_f32 v79, v79
    v_cvt_pk_bf16_f32 v90, v76, v77
    v_cvt_pk_bf16_f32 v91, v78, v79
    v_mfma_f32_32x32x16_bf16 v[160:175], v[224:227], v[208:211], v[160:175]
    v_exp_f32 v80, v80
    v_exp_f32 v81, v81
    v_exp_f32 v82, v82
    v_mfma_f32_32x32x16_bf16 v[12:27], v[136:139], v[88:91], v[12:27]
    v_exp_f32 v83, v83
    v_cvt_pk_bf16_f32 v92, v80, v81
    v_exp_f32 v84, v84
    v_exp_f32 v85, v85
    v_mfma_f32_32x32x16_bf16 v[176:191], v[228:231], v[208:211], v[176:191]
    s_waitcnt lgkmcnt(0)
    v_cvt_pk_bf16_f32 v93, v82, v83
    v_exp_f32 v86, v86
    v_exp_f32 v87, v87
    v_cvt_pk_bf16_f32 v94, v84, v85
    v_cvt_pk_bf16_f32 v95, v86, v87
    s_waitcnt vmcnt(11)
    s_barrier
    v_mfma_f32_32x32x16_bf16 v[72:87], v[112:115], v[144:147], 0
    s_setprio 3
    ds_read_b128 v[128:131], v34 offset:8192
    ds_read_b128 v[132:135], v34 offset:9216
    buffer_load_dwordx4 v[208:211], v1, s[40:43], s75 offen sc1
    v_exp_f32 v56, v56
    v_exp_f32 v57, v57
    v_exp_f32 v58, v58
    v_mfma_f32_32x32x16_bf16 v[12:27], v[140:143], v[92:95], v[12:27]
    ds_read_b128 v[136:139], v34 offset:10240
    ds_read_b64_tr_b16 v[224:225], v37 offset:16384
    ds_read_b64_tr_b16 v[226:227], v37 offset:17408
    s_add_u32 m0, s65, 90112
    s_add_u32 s74, s74, 14336
    buffer_load_dwordx4 v6, s[44:47], s74 offen lds
    v_exp_f32 v59, v59
    v_cvt_pk_bf16_f32 v88, v56, v57
    v_exp_f32 v60, v60
    v_exp_f32 v61, v61
    v_mfma_f32_32x32x16_bf16 v[72:87], v[116:119], v[148:151], v[72:87]
    ds_read_b128 v[140:143], v34 offset:11264
    ds_read_b64_tr_b16 v[228:229], v40 offset:16384
    ds_read_b64_tr_b16 v[230:231], v40 offset:17408
    s_add_u32 m0, s65, 98304
    s_add_u32 s74, s74, 14336
    buffer_load_dwordx4 v6, s[44:47], s74 offen lds
    v_cvt_pk_bf16_f32 v89, v58, v59
    v_exp_f32 v62, v62
    v_exp_f32 v63, v63
    v_cvt_pk_bf16_f32 v90, v60, v61
    v_cvt_pk_bf16_f32 v91, v62, v63
    v_mfma_f32_32x32x16_bf16 v[160:175], v[232:235], v[212:215], v[160:175]
    v_exp_f32 v64, v64
    v_exp_f32 v65, v65
    v_exp_f32 v66, v66
    v_mfma_f32_32x32x16_bf16 v[12:27], v[104:107], v[88:91], v[12:27]
    v_exp_f32 v67, v67
    v_cvt_pk_bf16_f32 v92, v64, v65
    v_exp_f32 v68, v68
    v_exp_f32 v69, v69
    v_mfma_f32_32x32x16_bf16 v[176:191], v[236:239], v[212:215], v[176:191]
    s_waitcnt lgkmcnt(0)
    v_cvt_pk_bf16_f32 v93, v66, v67
    v_exp_f32 v70, v70
    v_exp_f32 v71, v71
    v_cvt_pk_bf16_f32 v94, v68, v69
    v_cvt_pk_bf16_f32 v95, v70, v71
    v_mfma_f32_32x32x16_bf16 v[56:71], v[128:131], v[144:147], 0
    s_setprio 2
    ds_read_b128 v[96:99], v32
    ds_read_b128 v[100:103], v32 offset:1024
    buffer_load_dwordx4 v[212:215], v1, s[40:43], s75 offen offset:1024 sc1
    v_exp_f32 v72, v72
    v_exp_f32 v73, v73
    v_exp_f32 v74, v74
    v_mfma_f32_32x32x16_bf16 v[12:27], v[108:111], v[92:95], v[12:27]
    ds_read_b128 v[104:107], v32 offset:2048
    ds_read_b64_tr_b16 v[232:233], v35 offset:8192
    ds_read_b64_tr_b16 v[234:235], v35 offset:9216
    s_add_u32 m0, s65, 122880
    s_add_u32 s74, s74, 14336
    buffer_load_dwordx4 v6, s[44:47], s74 offen lds
    v_exp_f32 v75, v75
    v_cvt_pk_bf16_f32 v88, v72, v73
    v_exp_f32 v76, v76
    v_exp_f32 v77, v77
    v_mfma_f32_32x32x16_bf16 v[56:71], v[132:135], v[148:151], v[56:71]
    ds_read_b128 v[108:111], v32 offset:3072
    ds_read_b64_tr_b16 v[236:237], v38 offset:8192
    ds_read_b64_tr_b16 v[238:239], v38 offset:9216
    s_add_u32 m0, s65, 106496
    s_add_u32 s74, s74, 14336
    buffer_load_dwordx4 v6, s[44:47], s74 offen lds
    v_cvt_pk_bf16_f32 v89, v74, v75
    v_exp_f32 v78, v78
    v_exp_f32 v79, v79
    v_cvt_pk_bf16_f32 v90, v76, v77
    v_cvt_pk_bf16_f32 v91, v78, v79
    v_mfma_f32_32x32x16_bf16 v[160:175], v[224:227], v[216:219], v[160:175]
    v_exp_f32 v80, v80
    v_exp_f32 v81, v81
    v_exp_f32 v82, v82
    v_mfma_f32_32x32x16_bf16 v[12:27], v[120:123], v[88:91], v[12:27]
    v_exp_f32 v83, v83
    v_cvt_pk_bf16_f32 v92, v80, v81
    v_exp_f32 v84, v84
    v_exp_f32 v85, v85
    v_mfma_f32_32x32x16_bf16 v[176:191], v[228:231], v[216:219], v[176:191]
    s_waitcnt lgkmcnt(0)
    v_cvt_pk_bf16_f32 v93, v82, v83
    v_exp_f32 v86, v86
    v_exp_f32 v87, v87
    v_cvt_pk_bf16_f32 v94, v84, v85
    v_cvt_pk_bf16_f32 v95, v86, v87
    v_mfma_f32_32x32x16_bf16 v[72:87], v[96:99], v[144:147], 0
    s_setprio 1
    ds_read_b128 v[112:115], v32 offset:16384
    ds_read_b128 v[116:119], v32 offset:17408
    buffer_load_dwordx4 v[216:219], v1, s[40:43], s75 offen offset:2048 sc1
    v_exp_f32 v56, v56
    v_exp_f32 v57, v57
    v_exp_f32 v58, v58
    v_mfma_f32_32x32x16_bf16 v[12:27], v[124:127], v[92:95], v[12:27]
    ds_read_b128 v[120:123], v32 offset:18432
    ds_read_b64_tr_b16 v[224:225], v35 offset:24576
    ds_read_b64_tr_b16 v[226:227], v35 offset:25600
    s_add_u32 m0, s65, 131072
    s_add_u32 s74, s74, 14336
    buffer_load_dwordx4 v6, s[44:47], s74 offen lds
    v_exp_f32 v59, v59
    v_cvt_pk_bf16_f32 v88, v56, v57
    v_exp_f32 v60, v60
    v_exp_f32 v61, v61
    v_mfma_f32_32x32x16_bf16 v[72:87], v[100:103], v[148:151], v[72:87]
    ds_read_b128 v[124:127], v32 offset:19456
    ds_read_b64_tr_b16 v[228:229], v38 offset:24576
    ds_read_b64_tr_b16 v[230:231], v38 offset:25600
    s_add_u32 m0, s65, 114688
    s_add_u32 s74, s74, 14336
    buffer_load_dwordx4 v6, s[44:47], s74 offen lds
    v_cvt_pk_bf16_f32 v89, v58, v59
    v_exp_f32 v62, v62
    v_exp_f32 v63, v63
    v_cvt_pk_bf16_f32 v90, v60, v61
    v_cvt_pk_bf16_f32 v91, v62, v63
    v_mfma_f32_32x32x16_bf16 v[160:175], v[232:235], v[220:223], v[160:175]
    v_exp_f32 v64, v64
    v_exp_f32 v65, v65
    v_exp_f32 v66, v66
    v_mfma_f32_32x32x16_bf16 v[12:27], v[136:139], v[88:91], v[12:27]
    v_exp_f32 v67, v67
    v_cvt_pk_bf16_f32 v92, v64, v65
    v_exp_f32 v68, v68
    v_exp_f32 v69, v69
    v_mfma_f32_32x32x16_bf16 v[176:191], v[236:239], v[220:223], v[176:191]
    s_waitcnt lgkmcnt(0)
    v_cvt_pk_bf16_f32 v93, v66, v67
    v_exp_f32 v70, v70
    v_exp_f32 v71, v71
    v_cvt_pk_bf16_f32 v94, v68, v69
    v_cvt_pk_bf16_f32 v95, v70, v71
    s_waitcnt vmcnt(10)
    s_barrier
    v_mfma_f32_32x32x16_bf16 v[56:71], v[112:115], v[144:147], 0
    s_setprio 3
    ds_read_b128 v[128:131], v32 offset:40960
    ds_read_b128 v[132:135], v32 offset:41984
    buffer_load_dwordx4 v[220:223], v1, s[40:43], s75 offen offset:3072 sc1
    s_add_u32 s75, s75, 4096
    s_add_u32 m0, s65, 139264
    s_add_u32 s74, s74, 14336
    buffer_load_dwordx4 v6, s[44:47], s74 offen lds
    v_exp_f32 v72, v72
    v_exp_f32 v73, v73
    v_exp_f32 v74, v74
    v_mfma_f32_32x32x16_bf16 v[12:27], v[140:143], v[92:95], v[12:27]
    ds_read_b128 v[136:139], v32 offset:43008
    ds_read_b64_tr_b16 v[232:233], v35 offset:49152
    ds_read_b64_tr_b16 v[234:235], v35 offset:50176
    s_add_u32 m0, s65, 147456
    s_mul_i32 s86, s78, 129024
    s_sub_u32 s74, s74, s86
    s_sub_u32 s74, s74, 903168
    buffer_load_dwordx4 v6, s[48:51], s74 offen lds
    v_exp_f32 v75, v75
    v_cvt_pk_bf16_f32 v88, v72, v73
    v_exp_f32 v76, v76
    v_exp_f32 v77, v77
    v_mfma_f32_32x32x16_bf16 v[56:71], v[116:119], v[148:151], v[56:71]
    ds_read_b128 v[140:143], v32 offset:44032
    ds_read_b64_tr_b16 v[236:237], v38 offset:49152
    ds_read_b64_tr_b16 v[238:239], v38 offset:50176
    s_add_u32 m0, s65, 0
    s_add_u32 s74, s74, 14336
    buffer_load_dwordx4 v6, s[48:51], s74 offen lds
    v_cvt_pk_bf16_f32 v89, v74, v75
    v_exp_f32 v78, v78
    v_exp_f32 v79, v79
    v_cvt_pk_bf16_f32 v90, v76, v77
    v_cvt_pk_bf16_f32 v91, v78, v79
    v_mfma_f32_32x32x16_bf16 v[160:175], v[224:227], v[192:195], v[160:175]
    v_exp_f32 v80, v80
    v_exp_f32 v81, v81
    v_exp_f32 v82, v82
    v_mfma_f32_32x32x16_bf16 v[12:27], v[104:107], v[88:91], v[12:27]
    v_exp_f32 v83, v83
    v_cvt_pk_bf16_f32 v92, v80, v81
    v_exp_f32 v84, v84
    v_exp_f32 v85, v85
    v_mfma_f32_32x32x16_bf16 v[176:191], v[228:231], v[192:195], v[176:191]
    s_waitcnt lgkmcnt(0)
    v_cvt_pk_bf16_f32 v93, v82, v83
    v_exp_f32 v86, v86
    v_exp_f32 v87, v87
    v_cvt_pk_bf16_f32 v94, v84, v85
    v_cvt_pk_bf16_f32 v95, v86, v87
    v_mfma_f32_32x32x16_bf16 v[72:87], v[128:131], v[144:147], 0
    s_setprio 2
    ds_read_b128 v[96:99], v32 offset:57344
    ds_read_b128 v[100:103], v32 offset:58368
    buffer_load_dwordx4 v[192:195], v1, s[40:43], s75 offen sc1
    s_add_u32 m0, s65, 8192
    s_add_u32 s74, s74, 10752
    buffer_load_dwordx4 v6, s[48:51], s74 offen lds
    v_exp_f32 v56, v56
    v_exp_f32 v57, v57
    v_exp_f32 v58, v58
    v_mfma_f32_32x32x16_bf16 v[12:27], v[108:111], v[92:95], v[12:27]
    ds_read_b128 v[104:107], v32 offset:59392
    ds_read_b64_tr_b16 v[224:225], v36
    ds_read_b64_tr_b16 v[226:227], v36 offset:1024
    s_add_u32 m0, s65, 16384
    s_add_u32 s74, s74, 14336
    buffer_load_dwordx4 v6, s[48:51], s74 offen lds
    v_exp_f32 v59, v59
    v_cvt_pk_bf16_f32 v88, v56, v57
    v_exp_f32 v60, v60
    v_exp_f32 v61, v61
    v_mfma_f32_32x32x16_bf16 v[72:87], v[132:135], v[148:151], v[72:87]
    ds_read_b128 v[108:111], v32 offset:60416
    ds_read_b64_tr_b16 v[228:229], v39
    ds_read_b64_tr_b16 v[230:231], v39 offset:1024
    s_add_u32 m0, s65, 24576
    s_add_u32 s74, s74, 10752
    buffer_load_dwordx4 v6, s[48:51], s74 offen lds
    v_cvt_pk_bf16_f32 v89, v58, v59
    v_exp_f32 v62, v62
    v_exp_f32 v63, v63
    v_cvt_pk_bf16_f32 v90, v60, v61
    v_cvt_pk_bf16_f32 v91, v62, v63
    v_mfma_f32_32x32x16_bf16 v[160:175], v[232:235], v[196:199], v[160:175]
    v_exp_f32 v64, v64
    v_exp_f32 v65, v65
    v_exp_f32 v66, v66
    v_mfma_f32_32x32x16_bf16 v[12:27], v[120:123], v[88:91], v[12:27]
    v_exp_f32 v67, v67
    v_cvt_pk_bf16_f32 v92, v64, v65
    v_exp_f32 v68, v68
    v_exp_f32 v69, v69
    v_mfma_f32_32x32x16_bf16 v[176:191], v[236:239], v[196:199], v[176:191]
    s_waitcnt lgkmcnt(0)
    v_cvt_pk_bf16_f32 v93, v66, v67
    v_exp_f32 v70, v70
    v_exp_f32 v71, v71
    v_cvt_pk_bf16_f32 v94, v68, v69
    v_cvt_pk_bf16_f32 v95, v70, v71
    v_mfma_f32_32x32x16_bf16 v[56:71], v[96:99], v[144:147], 0
    s_setprio 1
    ds_read_b128 v[112:115], v32 offset:32768
    ds_read_b128 v[116:119], v32 offset:33792
    buffer_load_dwordx4 v[196:199], v1, s[40:43], s75 offen offset:1024 sc1
    v_exp_f32 v72, v72
    v_exp_f32 v73, v73
    v_exp_f32 v74, v74
    v_mfma_f32_32x32x16_bf16 v[12:27], v[124:127], v[92:95], v[12:27]
    ds_read_b128 v[120:123], v32 offset:34816
    ds_read_b64_tr_b16 v[232:233], v36 offset:16384
    ds_read_b64_tr_b16 v[234:235], v36 offset:17408
    v_exp_f32 v75, v75
    v_cvt_pk_bf16_f32 v88, v72, v73
    v_exp_f32 v76, v76
    v_exp_f32 v77, v77
    v_mfma_f32_32x32x16_bf16 v[56:71], v[100:103], v[148:151], v[56:71]
    ds_read_b128 v[124:127], v32 offset:35840
    ds_read_b64_tr_b16 v[236:237], v39 offset:16384
    ds_read_b64_tr_b16 v[238:239], v39 offset:17408
    v_cvt_pk_bf16_f32 v89, v74, v75
    v_exp_f32 v78, v78
    v_exp_f32 v79, v79
    v_cvt_pk_bf16_f32 v90, v76, v77
    v_cvt_pk_bf16_f32 v91, v78, v79
    v_mfma_f32_32x32x16_bf16 v[160:175], v[224:227], v[200:203], v[160:175]
    v_exp_f32 v80, v80
    v_exp_f32 v81, v81
    v_exp_f32 v82, v82
    v_mfma_f32_32x32x16_bf16 v[12:27], v[136:139], v[88:91], v[12:27]
    v_exp_f32 v83, v83
    v_cvt_pk_bf16_f32 v92, v80, v81
    v_exp_f32 v84, v84
    v_exp_f32 v85, v85
    v_mfma_f32_32x32x16_bf16 v[176:191], v[228:231], v[200:203], v[176:191]
    s_waitcnt lgkmcnt(0)
    v_cvt_pk_bf16_f32 v93, v82, v83
    v_exp_f32 v86, v86
    v_exp_f32 v87, v87
    v_cvt_pk_bf16_f32 v94, v84, v85
    v_cvt_pk_bf16_f32 v95, v86, v87
    s_waitcnt vmcnt(16)
    s_barrier
    v_mfma_f32_32x32x16_bf16 v[72:87], v[112:115], v[144:147], 0
    s_setprio 3
    ds_read_b64_tr_b16 v[224:225], v36 offset:8192
    ds_read_b64_tr_b16 v[226:227], v36 offset:9216
    buffer_load_dwordx4 v[200:203], v1, s[40:43], s75 offen offset:2048 sc1
    s_add_u32 m0, s65, 40960
    s_add_u32 s74, s74, 14336
    buffer_load_dwordx4 v6, s[48:51], s74 offen lds
    v_exp_f32 v56, v56
    v_exp_f32 v57, v57
    v_exp_f32 v58, v58
    v_mfma_f32_32x32x16_bf16 v[12:27], v[140:143], v[92:95], v[12:27]
    ds_read_b64_tr_b16 v[228:229], v39 offset:8192
    ds_read_b64_tr_b16 v[230:231], v39 offset:9216
    s_add_u32 m0, s65, 49152
    s_add_u32 s74, s74, 10752
    buffer_load_dwordx4 v6, s[48:51], s74 offen lds
    v_exp_f32 v59, v59
    v_cvt_pk_bf16_f32 v88, v56, v57
    v_exp_f32 v60, v60
    v_exp_f32 v61, v61
    v_mfma_f32_32x32x16_bf16 v[72:87], v[116:119], v[148:151], v[72:87]
    s_add_u32 m0, s65, 57344
    s_add_u32 s74, s74, 14336
    buffer_load_dwordx4 v6, s[48:51], s74 offen lds
    v_cvt_pk_bf16_f32 v89, v58, v59
    v_exp_f32 v62, v62
    v_exp_f32 v63, v63
    v_cvt_pk_bf16_f32 v90, v60, v61
    v_cvt_pk_bf16_f32 v91, v62, v63
    v_mfma_f32_32x32x16_bf16 v[160:175], v[232:235], v[204:207], v[160:175]
    v_exp_f32 v64, v64
    v_exp_f32 v65, v65
    v_exp_f32 v66, v66
    v_mfma_f32_32x32x16_bf16 v[12:27], v[104:107], v[88:91], v[12:27]
    v_exp_f32 v67, v67
    v_cvt_pk_bf16_f32 v92, v64, v65
    v_exp_f32 v68, v68
    v_exp_f32 v69, v69
    v_mfma_f32_32x32x16_bf16 v[176:191], v[236:239], v[204:207], v[176:191]
    s_waitcnt lgkmcnt(0)
    v_cvt_pk_bf16_f32 v93, v66, v67
    v_exp_f32 v70, v70
    v_exp_f32 v71, v71
    v_cvt_pk_bf16_f32 v94, v68, v69
    v_cvt_pk_bf16_f32 v95, v70, v71
    s_nop 0
    s_nop 0
    v_mfma_f32_32x32x16_bf16 v[12:27], v[108:111], v[92:95], v[12:27]
    s_setprio 1
    ds_read_b64_tr_b16 v[232:233], v36 offset:24576
    ds_read_b64_tr_b16 v[234:235], v36 offset:25600
    buffer_load_dwordx4 v[204:207], v1, s[40:43], s75 offen offset:3072 sc1
    s_add_u32 s75, s75, 4096
    v_exp_f32 v72, v72
    v_exp_f32 v73, v73
    v_exp_f32 v74, v74
    v_exp_f32 v75, v75
    v_cvt_pk_bf16_f32 v88, v72, v73
    v_exp_f32 v76, v76
    v_exp_f32 v77, v77
    v_cvt_pk_bf16_f32 v89, v74, v75
    v_exp_f32 v78, v78
    v_exp_f32 v79, v79
    v_cvt_pk_bf16_f32 v90, v76, v77
    v_cvt_pk_bf16_f32 v91, v78, v79
    v_mfma_f32_32x32x16_bf16 v[160:175], v[224:227], v[208:211], v[160:175]
    ds_read_b64_tr_b16 v[236:237], v39 offset:24576
    ds_read_b64_tr_b16 v[238:239], v39 offset:25600
    v_exp_f32 v80, v80
    v_exp_f32 v81, v81
    v_exp_f32 v82, v82
    v_mfma_f32_32x32x16_bf16 v[12:27], v[120:123], v[88:91], v[12:27]
    v_exp_f32 v83, v83
    v_cvt_pk_bf16_f32 v92, v80, v81
    v_exp_f32 v84, v84
    v_exp_f32 v85, v85
    v_mfma_f32_32x32x16_bf16 v[176:191], v[228:231], v[208:211], v[176:191]
    s_waitcnt lgkmcnt(0)
    s_waitcnt vmcnt(19)
    v_cvt_pk_bf16_f32 v93, v82, v83
    v_exp_f32 v86, v86
    v_exp_f32 v87, v87
    v_cvt_pk_bf16_f32 v94, v84, v85
    v_cvt_pk_bf16_f32 v95, v86, v87
    s_nop 0
    s_nop 0
    v_mfma_f32_32x32x16_bf16 v[12:27], v[124:127], v[92:95], v[12:27]
    s_setprio 0
    s_mov_b32 s86, 65536
    s_cmp_eq_u32 s63, 1
    s_cselect_b32 s87, 32768, s86
    s_cselect_b32 s86, s86, 32768
    s_cselect_b64 s[94:95], s[92:93], 0
    s_lshl_b32 s88, s64, 11
    s_add_u32 s86, s86, s88
    s_add_u32 s87, s87, s88
    v_add_u32 v32, s87, v1
    v_add_u32 v33, s86, v1
    s_lshl_b32 s86, s62, 8
    s_add_u32 s86, s86, 155648
    v_lshl_add_u32 v34, v0, 2, s86
    v_xor_b32 v41, 0x400, v34
    s_waitcnt vmcnt(1)
    v_mov_b32 v49, v24
    s_cmp_eq_u32 s63, 0
    s_cbranch_scc1 L_NOSWAP
    v_swap_b32 v12, v20
    v_swap_b32 v13, v21
    v_swap_b32 v14, v22
    v_swap_b32 v15, v23
    v_swap_b32 v16, v24
    v_swap_b32 v17, v25
    v_swap_b32 v18, v26
    v_swap_b32 v19, v27
L_NOSWAP:
    ds_write_b32 v34, v49
    ds_write_b128 v32, v[20:23]
    ds_write_b128 v32, v[24:27] offset:1024
    s_mov_b32 s87, 0x6d800000
    s_waitcnt lgkmcnt(0)
    s_barrier
    ds_read_b32 v48, v41
    ds_read_b128 v[20:23], v33
    ds_read_b128 v[24:27], v33 offset:1024
    s_waitcnt lgkmcnt(2)
    v_add_f32 v49, v49, v48
    v_mov_b32 v48, v49
    s_waitcnt lgkmcnt(1)
    v_add_f32 v12, v12, v20
    v_add_f32 v13, v13, v21
    v_add_f32 v14, v14, v22
    v_add_f32 v15, v15, v23
    v_permlane32_swap_b32 v48, v49
    s_waitcnt lgkmcnt(0)
    v_add_f32 v16, v16, v24
    v_add_f32 v17, v17, v25
    v_mul_f32 v48, 0x45800000, v49
    v_rcp_f32 v52, v48
    v_add_f32 v18, v18, v26
    v_add_f32 v19, v19, v27
    v_fma_f32 v50, v12, 0, v49
    v_mul_f32 v51, 0, v13
    v_mul_f32 v52, 0x39800000, v52
    v_cndmask_b32 v53, v52, 0, s[94:95]
    v_fmac_f32 v50, 0, v14
    v_fmac_f32 v51, 0, v15
    v_fmac_f32 v50, 0, v16
    v_fmac_f32 v51, 0, v17
    v_fmac_f32 v50, 0, v18
    v_fmac_f32 v51, 0, v19
    v_add_f32 v50, v50, v51
    v_mul_f32 v12, v12, v52
    v_mul_f32 v13, v13, v52
    v_mul_f32 v14, v14, v52
    v_mul_f32 v15, v15, v52
    v_cmp_nle_f32 vcc, 0x0b000000, v50
    v_cmp_nge_f32 s[4:5], s87, v50
    v_mul_f32 v16, v16, v53
    v_mul_f32 v17, v17, v52
    v_mul_f32 v18, v18, v52
    v_mul_f32 v19, v19, v52
    s_or_b64 vcc, vcc, s[4:5]
    s_cbranch_vccnz L_SLOW
L_FIN:
    v_cvt_pk_bf16_f32 v88, v12, v13
    v_cvt_pk_bf16_f32 v89, v14, v15
    v_cvt_pk_bf16_f32 v90, v16, v17
    v_cvt_pk_bf16_f32 v91, v18, v19
    v_or_b32 v88, 1, v88
    buffer_store_dwordx4 v[88:91], v1, s[40:43], s101 offen sc1
    s_add_u32 s75, s89, 131072
    s_add_u32 s73, s89, 262144
    s_add_u32 s74, s89, 393216
    v_mfma_f32_32x32x16_bf16 v[160:175], v[232:235], v[212:215], v[160:175]
    ds_read_b64_tr_b16 v[224:225], v36 offset:32768
    ds_read_b64_tr_b16 v[226:227], v36 offset:33792
    ds_read_b64_tr_b16 v[96:97], v37 offset:16384
    ds_read_b64_tr_b16 v[98:99], v37 offset:17408
    ds_read_b64_tr_b16 v[100:101], v40 offset:16384
    ds_read_b64_tr_b16 v[102:103], v40 offset:17408
    v_mfma_f32_32x32x16_bf16 v[176:191], v[236:239], v[212:215], v[176:191]
    ds_read_b64_tr_b16 v[228:229], v39 offset:32768
    ds_read_b64_tr_b16 v[230:231], v39 offset:33792
    ds_read_b64_tr_b16 v[104:105], v35
    ds_read_b64_tr_b16 v[106:107], v35 offset:1024
    ds_read_b64_tr_b16 v[108:109], v38
    ds_read_b64_tr_b16 v[110:111], v38 offset:1024
    s_waitcnt lgkmcnt(10)
    v_mfma_f32_32x32x16_bf16 v[160:175], v[224:227], v[216:219], v[160:175]
    ds_read_b64_tr_b16 v[232:233], v36 offset:57344
    ds_read_b64_tr_b16 v[234:235], v36 offset:58368
    ds_read_b64_tr_b16 v[112:113], v35 offset:8192
    ds_read_b64_tr_b16 v[114:115], v35 offset:9216
    ds_read_b64_tr_b16 v[116:117], v38 offset:8192
    ds_read_b64_tr_b16 v[118:119], v38 offset:9216
    s_waitcnt lgkmcnt(10)
    v_mfma_f32_32x32x16_bf16 v[176:191], v[228:231], v[216:219], v[176:191]
    ds_read_b64_tr_b16 v[236:237], v39 offset:57344
    ds_read_b64_tr_b16 v[238:239], v39 offset:58368
    ds_read_b64_tr_b16 v[120:121], v35 offset:16384
    ds_read_b64_tr_b16 v[122:123], v35 offset:17408
    ds_read_b64_tr_b16 v[124:125], v38 offset:16384
    ds_read_b64_tr_b16 v[126:127], v38 offset:17408
    s_waitcnt lgkmcnt(10)
    v_mfma_f32_32x32x16_bf16 v[160:175], v[232:235], v[220:223], v[160:175]
    ds_read_b64_tr_b16 v[224:225], v36 offset:40960
    ds_read_b64_tr_b16 v[226:227], v36 offset:41984
    ds_read_b64_tr_b16 v[128:129], v35 offset:24576
    ds_read_b64_tr_b16 v[130:131], v35 offset:25600
    ds_read_b64_tr_b16 v[132:133], v38 offset:24576
    ds_read_b64_tr_b16 v[134:135], v38 offset:25600
    s_waitcnt lgkmcnt(10)
    v_mfma_f32_32x32x16_bf16 v[176:191], v[236:239], v[220:223], v[176:191]
    ds_read_b64_tr_b16 v[228:229], v39 offset:40960
    ds_read_b64_tr_b16 v[230:231], v39 offset:41984
    ds_read_b64_tr_b16 v[136:137], v35 offset:40960
    ds_read_b64_tr_b16 v[138:139], v35 offset:41984
    ds_read_b64_tr_b16 v[140:141], v38 offset:40960
    ds_read_b64_tr_b16 v[142:143], v38 offset:41984
    s_waitcnt lgkmcnt(10)
    v_mfma_f32_32x32x16_bf16 v[160:175], v[224:227], v[192:195], v[160:175]
    ds_read_b64_tr_b16 v[232:233], v37
    ds_read_b64_tr_b16 v[234:235], v37 offset:1024
    ds_read_b64_tr_b16 v[144:145], v35 offset:49152
    ds_read_b64_tr_b16 v[146:147], v35 offset:50176
    ds_read_b64_tr_b16 v[148:149], v38 offset:49152
    ds_read_b64_tr_b16 v[150:151], v38 offset:50176
    buffer_load_dwordx4 v[56:59], v1, s[40:43], s89 offen sc1
    s_waitcnt lgkmcnt(10)
    v_mfma_f32_32x32x16_bf16 v[176:191], v[228:231], v[192:195], v[176:191]
    ds_read_b64_tr_b16 v[236:237], v40
    ds_read_b64_tr_b16 v[238:239], v40 offset:1024
    ds_read_b64_tr_b16 v[152:153], v35 offset:57344
    ds_read_b64_tr_b16 v[154:155], v35 offset:58368
    ds_read_b64_tr_b16 v[156:157], v38 offset:57344
    ds_read_b64_tr_b16 v[158:159], v38 offset:58368
    buffer_load_dwordx4 v[60:63], v1, s[40:43], s89 offen offset:1024 sc1
    s_waitcnt lgkmcnt(10)
    v_mfma_f32_32x32x16_bf16 v[160:175], v[232:235], v[196:199], v[160:175]
    ds_read_b64_tr_b16 v[224:225], v36 offset:49152
    ds_read_b64_tr_b16 v[226:227], v36 offset:50176
    buffer_load_dwordx4 v[64:67], v1, s[40:43], s75 offen sc1
    s_waitcnt lgkmcnt(6)
    v_mfma_f32_32x32x16_bf16 v[176:191], v[236:239], v[196:199], v[176:191]
    ds_read_b64_tr_b16 v[228:229], v39 offset:49152
    ds_read_b64_tr_b16 v[230:231], v39 offset:50176
    buffer_load_dwordx4 v[68:71], v1, s[40:43], s75 offen offset:1024 sc1
    s_waitcnt lgkmcnt(2)
    v_mfma_f32_32x32x16_bf16 v[160:175], v[224:227], v[200:203], v[160:175]
    ds_read_b64_tr_b16 v[232:233], v37 offset:8192
    ds_read_b64_tr_b16 v[234:235], v37 offset:9216
    buffer_load_dwordx4 v[72:75], v1, s[40:43], s73 offen sc1
    s_waitcnt lgkmcnt(2)
    v_mfma_f32_32x32x16_bf16 v[176:191], v[228:231], v[200:203], v[176:191]
    ds_read_b64_tr_b16 v[236:237], v40 offset:8192
    ds_read_b64_tr_b16 v[238:239], v40 offset:9216
    buffer_load_dwordx4 v[76:79], v1, s[40:43], s73 offen offset:1024 sc1
    s_waitcnt vmcnt(7) lgkmcnt(2)
    v_mfma_f32_32x32x16_bf16 v[160:175], v[232:235], v[204:207], v[160:175]
    buffer_load_dwordx4 v[80:83], v1, s[40:43], s74 offen sc1
    s_waitcnt lgkmcnt(0)
    v_mfma_f32_32x32x16_bf16 v[176:191], v[236:239], v[204:207], v[176:191]
    buffer_load_dwordx4 v[84:87], v1, s[40:43], s74 offen offset:1024 sc1
    v_lshlrev_b32 v16, 16, v240
    v_and_b32 v17, 0xffff0000, v240
    v_lshlrev_b32 v18, 16, v241
    v_and_b32 v19, 0xffff0000, v241
    v_lshlrev_b32 v20, 16, v242
    v_and_b32 v21, 0xffff0000, v242
    v_lshlrev_b32 v22, 16, v243
    v_and_b32 v23, 0xffff0000, v243
    s_barrier
    s_cmp_ge_u32 s2, 224
    s_cselect_b32 s88, 15, 0
    s_mov_b32 s90, 100000
L_OP:
    s_waitcnt vmcnt(6)
    s_bitcmp1_b32 s88, 0
    s_cbranch_scc1 L_ON0
    v_and_b32 v48, v56, v60
    v_and_b32 v48, 1, v48
    v_cmp_eq_u32 vcc, 0, v48
    s_nop 1
    s_cbranch_vccnz L_ON0
    v_mfma_f32_32x32x16_bf16 v[160:175], v[96:99], v[56:59], v[160:175]
    v_mfma_f32_32x32x16_bf16 v[176:191], v[100:103], v[56:59], v[176:191]
    v_mfma_f32_32x32x16_bf16 v[160:175], v[104:107], v[60:63], v[160:175]
    v_mfma_f32_32x32x16_bf16 v[176:191], v[108:111], v[60:63], v[176:191]
    s_bitset1_b32 s88, 0
L_ON0:
    s_waitcnt vmcnt(4)
    s_bitcmp1_b32 s88, 1
    s_cbranch_scc1 L_ON1
    v_and_b32 v48, v64, v68
    v_and_b32 v48, 1, v48
    v_cmp_eq_u32 vcc, 0, v48
    s_nop 1
    s_cbranch_vccnz L_ON1
    v_mfma_f32_32x32x16_bf16 v[160:175], v[112:115], v[64:67], v[160:175]
    v_mfma_f32_32x32x16_bf16 v[176:191], v[116:119], v[64:67], v[176:191]
    v_mfma_f32_32x32x16_bf16 v[160:175], v[120:123], v[68:71], v[160:175]
    v_mfma_f32_32x32x16_bf16 v[176:191], v[124:127], v[68:71], v[176:191]
    s_bitset1_b32 s88, 1
L_ON1:
    s_waitcnt vmcnt(2)
    s_bitcmp1_b32 s88, 2
    s_cbranch_scc1 L_ON2
    v_and_b32 v48, v72, v76
    v_and_b32 v48, 1, v48
    v_cmp_eq_u32 vcc, 0, v48
    s_nop 1
    s_cbranch_vccnz L_ON2
    v_mfma_f32_32x32x16_bf16 v[160:175], v[128:131], v[72:75], v[160:175]
    v_mfma_f32_32x32x16_bf16 v[176:191], v[132:135], v[72:75], v[176:191]
    v_mfma_f32_32x32x16_bf16 v[160:175], v[136:139], v[76:79], v[160:175]
    v_mfma_f32_32x32x16_bf16 v[176:191], v[140:143], v[76:79], v[176:191]
    s_bitset1_b32 s88, 2
L_ON2:
    s_waitcnt vmcnt(0)
    s_bitcmp1_b32 s88, 3
    s_cbranch_scc1 L_ON3
    v_and_b32 v48, v80, v84
    v_and_b32 v48, 1, v48
    v_cmp_eq_u32 vcc, 0, v48
    s_nop 1
    s_cbranch_vccnz L_ON3
    v_mfma_f32_32x32x16_bf16 v[160:175], v[144:147], v[80:83], v[160:175]
    v_mfma_f32_32x32x16_bf16 v[176:191], v[148:151], v[80:83], v[176:191]
    v_mfma_f32_32x32x16_bf16 v[160:175], v[152:155], v[84:87], v[160:175]
    v_mfma_f32_32x32x16_bf16 v[176:191], v[156:159], v[84:87], v[176:191]
    s_bitset1_b32 s88, 3
L_ON3:
    s_cmp_eq_u32 s88, 15
    s_cbranch_scc1 L_OD
    s_sleep 2
    s_bitcmp1_b32 s88, 0
    s_cbranch_scc1 L_OR0
    buffer_load_dwordx4 v[56:59], v1, s[40:43], s89 offen offset:0 sc1
    buffer_load_dwordx4 v[60:63], v1, s[40:43], s89 offen offset:1024 sc1
L_OR0:
    s_bitcmp1_b32 s88, 1
    s_cbranch_scc1 L_OR1
    buffer_load_dwordx4 v[64:67], v1, s[40:43], s75 offen offset:0 sc1
    buffer_load_dwordx4 v[68:71], v1, s[40:43], s75 offen offset:1024 sc1
L_OR1:
    s_bitcmp1_b32 s88, 2
    s_cbranch_scc1 L_OR2
    buffer_load_dwordx4 v[72:75], v1, s[40:43], s73 offen offset:0 sc1
    buffer_load_dwordx4 v[76:79], v1, s[40:43], s73 offen offset:1024 sc1
L_OR2:
    s_bitcmp1_b32 s88, 3
    s_cbranch_scc1 L_OR3
    buffer_load_dwordx4 v[80:83], v1, s[40:43], s74 offen offset:0 sc1
    buffer_load_dwordx4 v[84:87], v1, s[40:43], s74 offen offset:1024 sc1
L_OR3:
    s_sub_u32 s90, s90, 1
    s_waitcnt vmcnt(0)
    s_cbranch_scc0 L_OP
L_OD:
    s_nop 9
    ds_write_b128 v45, v[160:163]
    ds_write_b128 v45, v[164:167] offset:32
    ds_write_b128 v45, v[168:171] offset:64
    ds_write_b128 v45, v[172:175] offset:96
    ds_write_b128 v45, v[176:179] offset:128
    ds_write_b128 v45, v[180:183] offset:160
    ds_write_b128 v45, v[184:187] offset:192
    ds_write_b128 v45, v[188:191] offset:224
    s_waitcnt lgkmcnt(0)
    s_barrier
    ds_read_b128 v[192:195], v44
    ds_read_b128 v[196:199], v44 offset:16
    ds_read_b128 v[200:203], v44 offset:17408
    ds_read_b128 v[204:207], v44 offset:17424
    ds_read_b128 v[208:211], v44 offset:34816
    ds_read_b128 v[212:215], v44 offset:34832
    ds_read_b128 v[216:219], v44 offset:52224
    ds_read_b128 v[220:223], v44 offset:52240
    s_waitcnt lgkmcnt(7)
    v_add_f32 v16, v16, v192
    v_add_f32 v17, v17, v193
    v_add_f32 v18, v18, v194
    v_add_f32 v19, v19, v195
    s_waitcnt lgkmcnt(6)
    v_add_f32 v20, v20, v196
    v_add_f32 v21, v21, v197
    v_add_f32 v22, v22, v198
    v_add_f32 v23, v23, v199
    s_waitcnt lgkmcnt(5)
    v_add_f32 v16, v16, v200
    v_add_f32 v17, v17, v201
    v_add_f32 v18, v18, v202
    v_add_f32 v19, v19, v203
    s_waitcnt lgkmcnt(4)
    v_add_f32 v20, v20, v204
    v_add_f32 v21, v21, v205
    v_add_f32 v22, v22, v206
    v_add_f32 v23, v23, v207
    s_waitcnt lgkmcnt(3)
    v_add_f32 v16, v16, v208
    v_add_f32 v17, v17, v209
    v_add_f32 v18, v18, v210
    v_add_f32 v19, v19, v211
    s_waitcnt lgkmcnt(2)
    v_add_f32 v20, v20, v212
    v_add_f32 v21, v21, v213
    v_add_f32 v22, v22, v214
    v_add_f32 v23, v23, v215
    s_waitcnt lgkmcnt(1)
    v_add_f32 v16, v16, v216
    v_add_f32 v17, v17, v217
    v_add_f32 v18, v18, v218
    v_add_f32 v19, v19, v219
    s_waitcnt lgkmcnt(0)
    v_add_f32 v20, v20, v220
    v_add_f32 v21, v21, v221
    v_add_f32 v22, v22, v222
    v_add_f32 v23, v23, v223
    v_cvt_pk_bf16_f32 v12, v16, v17
    v_cvt_pk_bf16_f32 v13, v18, v19
    v_cvt_pk_bf16_f32 v14, v20, v21
    v_cvt_pk_bf16_f32 v15, v22, v23
    buffer_store_dwordx4 v[12:15], v43, s[52:55], s91 offen sc1
L_END:
    s_endpgm
L_VTYPE:
    v_and_b32 v220, 12, v0
    v_lshlrev_b32 v220, 4, v220
    s_mul_i32 s86, s63, 112
    v_add_u32 v15, s86, v10
    v_xor_b32 v15, v15, v220
    v_add3_u32 v15, v15, v9, v9
    s_xor_b32 s87, s96, 0
    s_lshl_b32 s87, s87, 12
    v_add_u32 v12, s87, v15
    s_xor_b32 s87, s96, 1
    s_lshl_b32 s87, s87, 12
    v_add_u32 v13, s87, v15
    s_xor_b32 s87, s96, 2
    s_lshl_b32 s87, s87, 12
    v_add_u32 v14, s87, v15
    s_xor_b32 s87, s96, 3
    s_lshl_b32 s87, s87, 12
    v_add_u32 v15, s87, v15
    s_add_u32 s86, s86, 56
    v_add_u32 v27, s86, v10
    v_xor_b32 v27, v27, v220
    v_add3_u32 v27, v27, v9, v9
    s_xor_b32 s87, s96, 0
    s_lshl_b32 s87, s87, 12
    v_add_u32 v24, s87, v27
    s_xor_b32 s87, s96, 1
    s_lshl_b32 s87, s87, 12
    v_add_u32 v25, s87, v27
    s_xor_b32 s87, s96, 2
    s_lshl_b32 s87, s87, 12
    v_add_u32 v26, s87, v27
    s_xor_b32 s87, s96, 3
    s_lshl_b32 s87, s87, 12
    v_add_u32 v27, s87, v27
    v_mov_b32 v204, 0
    v_mov_b32 v205, 0
    v_mov_b32 v206, 0
    v_mov_b32 v207, 0
    s_lshl_b32 s87, s68, 1
    s_add_u32 s10, s10, s87
    s_cmp_lt_u32 s61, 6
    s_cselect_b32 s86, s4, 0x7ff00000
    buffer_load_dword v216, v2, s[24:27], s86 offen
    s_cmp_lt_u32 s60, 6
    s_cselect_b32 s86, s10, 0x7ff00000
    buffer_load_dword v216, v4, s[32:35], s86 offen
    s_cmp_lt_u32 s60, 3
    s_cselect_b32 s86, s5, 0x7ff00000
    buffer_load_dword v216, v3, s[28:31], s86 offen
    s_add_u32 m0, s65, 40960
    s_add_u32 s67, s67, s68
    buffer_load_dwordx4 v2, s[24:27], s91 offen lds
    s_add_u32 m0, s65, 49152
    s_add_u32 s91, s91, 57344
    buffer_load_dwordx4 v2, s[24:27], s91 offen lds
    s_add_u32 m0, s65, 57344
    s_sub_u32 s91, s91, 57216
    buffer_load_dwordx4 v3, s[28:31], s66 offen lds
    s_add_u32 m0, s65, 65536
    s_add_u32 s66, s66, 172032
    buffer_load_dwordx4 v4, s[32:35], s67 offen lds
    s_add_u32 m0, s65, 73728
    s_add_u32 s67, s67, 86016
    buffer_load_dwordx4 v4, s[32:35], s67 offen lds
    s_waitcnt vmcnt(8)
    s_barrier
    ds_read_b128 v[32:35], v16
    ds_read_b64_tr_b16 v[224:225], v20 offset:16384
    ds_read_b64_tr_b16 v[226:227], v20 offset:16896
    ds_read_b64_tr_b16 v[228:229], v12 offset:24576
    ds_read_b64_tr_b16 v[230:231], v12 offset:25600
    ds_read_b64_tr_b16 v[232:233], v24 offset:24576
    ds_read_b64_tr_b16 v[234:235], v24 offset:25600
    s_waitcnt lgkmcnt(4)
    v_mfma_f32_32x32x16_bf16 v[144:159], v[224:227], v[32:35], 0
    s_setprio 3
    ds_read_b128 v[36:39], v17
    ds_read_b64_tr_b16 v[236:237], v21 offset:16384
    ds_read_b64_tr_b16 v[238:239], v21 offset:16896
    s_add_u32 m0, s65, 81920
    s_add_u32 s67, s67, 86016
    buffer_load_dwordx4 v2, s[24:27], s91 offen lds
    s_waitcnt lgkmcnt(5)
    v_mfma_f32_32x32x16_bf16 v[160:175], v[32:35], v[228:231], 0
    ds_read_b64_tr_b16 v[240:241], v13 offset:24576
    ds_read_b64_tr_b16 v[242:243], v13 offset:25600
    s_waitcnt lgkmcnt(5)
    v_mfma_f32_32x32x16_bf16 v[176:191], v[32:35], v[232:235], 0
    ds_read_b64_tr_b16 v[244:245], v25 offset:24576
    ds_read_b64_tr_b16 v[246:247], v25 offset:25600
    s_mov_b32 s40, s22
    s_mov_b32 s41, s23
    s_mov_b32 s42, 0x1800000
    s_mov_b32 s43, 0x20000
    s_mov_b32 s44, s16
    s_mov_b32 s45, s17
    s_mov_b32 s46, 0x188000
    s_mov_b32 s47, 0x20000
    s_mov_b32 s48, s8
    s_mov_b32 s49, s9
    s_mov_b32 s50, 0x62000
    s_mov_b32 s51, 0x20000
    s_mov_b32 s52, s18
    s_mov_b32 s53, s19
    s_mov_b32 s54, 0x1c0000
    s_mov_b32 s55, 0x20000
    s_mov_b32 s56, s20
    s_mov_b32 s57, s21
    s_mov_b32 s58, 0x100
    s_mov_b32 s59, 0x20000
    v_lshlrev_b32 v1, 4, v0
    v_mfma_f32_16x16x32_bf16 v[192:195], v[28:31], v[224:227], 0
    v_lshlrev_b32 v208, 16, v32
    v_and_b32 v209, 0xffff0000, v32
    v_lshlrev_b32 v210, 16, v33
    v_and_b32 v211, 0xffff0000, v33
    v_add_f32 v204, v204, v208
    v_add_f32 v205, v205, v209
    v_fmac_f32 v206, v208, v208
    v_fmac_f32 v207, v209, v209
    v_add_f32 v204, v204, v210
    v_add_f32 v205, v205, v211
    v_fmac_f32 v206, v210, v210
    v_fmac_f32 v207, v211, v211
    s_waitcnt lgkmcnt(0)
    v_mfma_f32_32x32x16_bf16 v[144:159], v[236:239], v[36:39], v[144:159]
    s_setprio 2
    ds_read_b128 v[40:43], v18
    ds_read_b64_tr_b16 v[224:225], v22 offset:16384
    ds_read_b64_tr_b16 v[226:227], v22 offset:16896
    s_add_u32 m0, s65, 90112
    s_add_u32 s91, s91, 57344
    buffer_load_dwordx4 v2, s[24:27], s91 offen lds
    v_mfma_f32_32x32x16_bf16 v[160:175], v[36:39], v[240:243], v[160:175]
    ds_read_b64_tr_b16 v[228:229], v14 offset:24576
    ds_read_b64_tr_b16 v[230:231], v14 offset:25600
    s_add_u32 m0, s65, 98304
    s_sub_u32 s91, s91, 57216
    buffer_load_dwordx4 v3, s[28:31], s66 offen lds
    v_mfma_f32_32x32x16_bf16 v[176:191], v[36:39], v[244:247], v[176:191]
    ds_read_b64_tr_b16 v[232:233], v26 offset:24576
    ds_read_b64_tr_b16 v[234:235], v26 offset:25600
    s_sub_u32 s87, s2, 0
    s_lshl_b32 s86, s87, 3
    s_add_u32 s86, s86, s62
    s_mul_i32 s86, s86, 1024
    s_add_u32 s86, s86, 0xf00000
    s_mul_i32 s9, s87, 16
    s_cmp_lt_u32 s87, 16
    s_cselect_b32 s86, s86, 0x7ff00000
    s_cselect_b32 s9, s9, 0x1000
    v_mov_b32 v212, 0
    v_mov_b32 v213, 0
    v_mov_b32 v214, 0
    v_mov_b32 v215, 0
    s_cbranch_scc0 L_G12
    buffer_store_dwordx4 v[212:215], v1, s[40:43], s86 offen sc1
L_G12:
    v_or_b32 v222, s62, v0
    v_cmp_eq_u32 vcc, 0, v222
    v_mov_b32 v222, 0x7ffffff0
    s_nop 0
    v_cndmask_b32 v7, v222, 0, vcc
    v_cmp_lt_u32 s[92:93], 31, v0
    v_mov_b32 v248, 1
    v_mfma_f32_16x16x32_bf16 v[196:199], v[28:31], v[240:243], 0
    v_lshlrev_b32 v208, 16, v34
    v_and_b32 v209, 0xffff0000, v34
    v_lshlrev_b32 v210, 16, v35
    v_and_b32 v211, 0xffff0000, v35
    v_add_f32 v204, v204, v208
    v_add_f32 v205, v205, v209
    v_fmac_f32 v206, v208, v208
    v_fmac_f32 v207, v209, v209
    v_add_f32 v204, v204, v210
    v_add_f32 v205, v205, v211
    v_fmac_f32 v206, v210, v210
    v_fmac_f32 v207, v211, v211
    s_waitcnt lgkmcnt(0)
    v_mfma_f32_32x32x16_bf16 v[144:159], v[224:227], v[40:43], v[144:159]
    s_setprio 1
    ds_read_b128 v[44:47], v19
    ds_read_b64_tr_b16 v[236:237], v23 offset:16384
    ds_read_b64_tr_b16 v[238:239], v23 offset:16896
    s_add_u32 m0, s65, 106496
    s_add_u32 s66, s66, 172032
    buffer_load_dwordx4 v4, s[32:35], s67 offen lds
    v_mfma_f32_32x32x16_bf16 v[160:175], v[40:43], v[228:231], v[160:175]
    ds_read_b64_tr_b16 v[240:241], v15 offset:24576
    ds_read_b64_tr_b16 v[242:243], v15 offset:25600
    v_mfma_f32_32x32x16_bf16 v[176:191], v[40:43], v[232:235], v[176:191]
    ds_read_b64_tr_b16 v[244:245], v27 offset:24576
    ds_read_b64_tr_b16 v[246:247], v27 offset:25600
    s_and_b32 s86, s2, 7
    s_lshr_b32 s87, s2, 3
    s_lshl_b32 s71, s86, 1
    s_lshr_b32 s88, s87, 4
    s_add_u32 s71, s71, s88
    s_and_b32 s72, s87, 15
    s_sub_u32 s88, s87, 4
    s_cmp_ge_u32 s87, 28
    s_cselect_b32 s87, s88, s87
    s_cselect_b32 s54, 0, s54
    s_mul_i32 s76, s87, 37
    s_lshr_b32 s76, s76, 8
    s_mul_i32 s88, s76, 7
    s_sub_u32 s77, s87, s88
    s_lshl_b32 s86, s86, 2
    s_add_u32 s76, s76, s86
    v_mfma_f32_16x16x32_bf16 v[200:203], v[28:31], v[232:235], 0
    v_lshlrev_b32 v208, 16, v40
    v_and_b32 v209, 0xffff0000, v40
    v_lshlrev_b32 v210, 16, v41
    v_and_b32 v211, 0xffff0000, v41
    v_add_f32 v204, v204, v208
    v_add_f32 v205, v205, v209
    v_fmac_f32 v206, v208, v208
    v_fmac_f32 v207, v209, v209
    v_add_f32 v204, v204, v210
    v_add_f32 v205, v205, v211
    v_fmac_f32 v206, v210, v210
    v_fmac_f32 v207, v211, v211
    v_add_u32 v12, 0x10000, v12
    v_add_u32 v24, 0x10000, v24
    s_waitcnt vmcnt(4)
    s_waitcnt lgkmcnt(0)
    s_barrier
    v_mfma_f32_32x32x16_bf16 v[144:159], v[236:239], v[44:47], v[144:159]
    s_setprio 3
    ds_read_b128 v[48:51], v16 offset:40960
    ds_read_b64_tr_b16 v[224:225], v20 offset:57344
    ds_read_b64_tr_b16 v[226:227], v20 offset:57856
    s_add_u32 m0, s65, 114688
    s_add_u32 s67, s67, 86016
    buffer_load_dwordx4 v4, s[32:35], s67 offen lds
    v_mfma_f32_32x32x16_bf16 v[160:175], v[44:47], v[240:243], v[160:175]
    ds_read_b64_tr_b16 v[228:229], v12
    ds_read_b64_tr_b16 v[230:231], v12 offset:1024
    s_add_u32 m0, s65, 122880
    s_add_u32 s67, s67, 86016
    buffer_load_dwordx4 v2, s[24:27], s91 offen lds
    s_sub_u32 s86, s2, 128
    s_cmp_lt_u32 s86, 32
    s_cbranch_scc0 L_Z13
    s_lshl_b32 s86, s86, 3
    s_add_u32 s86, s86, s62
    s_mul_i32 s86, s86, 7168
    v_and_b32 v217, 3, v0
    v_min_u32 v217, 2, v217
    v_lshlrev_b32 v217, 7, v217
    v_bfe_u32 v218, v0, 2, 3
    v_mul_u32_u24 v218, 896, v218
    v_add_u32 v217, v217, v218
    buffer_load_dword v216, v217, s[24:27], s86 offen offset:512
L_Z13:
    s_sub_u32 s86, s2, 160
    s_cmp_lt_u32 s86, 32
    s_cbranch_scc0 L_Z14
    s_lshl_b32 s86, s86, 3
    s_add_u32 s86, s86, s62
    s_lshl_b32 s86, s86, 11
    s_add_u32 s86, s86, 688128
    v_and_b32 v217, 15, v0
    v_lshlrev_b32 v217, 7, v217
    buffer_load_dword v216, v217, s[28:31], s86 offen
L_Z14:
    s_sub_u32 s86, s2, 192
    s_cmp_lt_u32 s86, 32
    s_cbranch_scc0 L_Z15
    s_lshl_b32 s86, s86, 2
    s_lshl_b32 s87, s63, 1
    s_add_u32 s86, s86, s87
    s_add_u32 s86, s86, s79
    s_mul_i32 s86, s86, 7168
    s_add_u32 s86, s86, 917504
    v_and_b32 v217, 15, v0
    v_min_u32 v217, 11, v217
    v_lshlrev_b32 v217, 7, v217
    v_bfe_u32 v218, v0, 4, 1
    v_mul_u32_u24 v218, 3584, v218
    v_add_u32 v217, v217, v218
    buffer_load_dword v216, v217, s[36:39], s86 offen
L_Z15:
    v_mfma_f32_32x32x16_bf16 v[176:191], v[44:47], v[244:247], v[176:191]
    ds_read_b64_tr_b16 v[232:233], v24
    ds_read_b64_tr_b16 v[234:235], v24 offset:1024
    s_lshr_b32 s78, s62, 1
    s_lshl_b32 s70, s60, 2
    s_add_u32 s70, s70, s64
    s_lshl_b32 s82, s72, 2
    s_add_u32 s82, s82, s64
    s_lshl_b32 s81, s71, 18
    s_add_u32 s81, s81, 0x200000
    s_add_u32 s73, s81, s65
    s_mul_i32 s74, s78, 172032
    s_mul_i32 s86, s79, 7168
    s_add_u32 s74, s74, s86
    s_lshl_b32 s86, s77, 7
    s_add_u32 s74, s74, s86
    s_cmp_ge_u32 s2, 224
    s_cselect_b32 s74, 0x70000000, s74
    v_lshlrev_b32 v208, 16, v42
    v_and_b32 v209, 0xffff0000, v42
    v_lshlrev_b32 v210, 16, v43
    v_and_b32 v211, 0xffff0000, v43
    v_add_f32 v204, v204, v208
    v_add_f32 v205, v205, v209
    v_fmac_f32 v206, v208, v208
    v_fmac_f32 v207, v209, v209
    v_add_f32 v204, v204, v210
    v_add_f32 v205, v205, v211
    v_fmac_f32 v206, v210, v210
    v_fmac_f32 v207, v211, v211
    v_add_u32 v13, 0x10000, v13
    v_add_u32 v25, 0x10000, v25
    s_waitcnt lgkmcnt(0)
    v_mfma_f32_32x32x16_bf16 v[144:159], v[224:227], v[48:51], v[144:159]
    s_setprio 2
    ds_read_b128 v[52:55], v17 offset:40960
    ds_read_b64_tr_b16 v[236:237], v21 offset:57344
    ds_read_b64_tr_b16 v[238:239], v21 offset:57856
    s_add_u32 m0, s65, 131072
    s_add_u32 s91, s91, 57344
    buffer_load_dwordx4 v2, s[24:27], s91 offen lds
    v_mfma_f32_32x32x16_bf16 v[160:175], v[48:51], v[228:231], v[160:175]
    ds_read_b64_tr_b16 v[240:241], v13
    ds_read_b64_tr_b16 v[242:243], v13 offset:1024
    v_mfma_f32_32x32x16_bf16 v[176:191], v[48:51], v[232:235], v[176:191]
    ds_read_b64_tr_b16 v[244:245], v25
    ds_read_b64_tr_b16 v[246:247], v25 offset:1024
    s_lshl_b32 s86, s100, 4
    s_add_u32 s86, s86, s60
    s_lshl_b32 s86, s86, 2
    s_add_u32 s83, s86, 0x0
    s_lshl_b32 s87, s97, 4
    s_add_u32 s87, s87, s60
    s_lshl_b32 s87, s87, 2
    s_add_u32 s87, s87, 0x400
    s_lshl_b32 s86, s60, 5
    s_add_u32 s86, s86, s61
    s_lshl_b32 s86, s86, 2
    s_add_u32 s85, s86, 0x830
    s_lshl_b32 s84, s97, 2
    s_sub_u32 s84, s85, s84
    s_sub_u32 s84, s84, 48
    s_cmp_ge_u32 s2, 192
    s_cselect_b32 s84, s87, s84
    v_mfma_f32_16x16x32_bf16 v[192:195], v[28:31], v[224:227], v[192:195]
    v_lshlrev_b32 v208, 16, v48
    v_and_b32 v209, 0xffff0000, v48
    v_lshlrev_b32 v210, 16, v49
    v_and_b32 v211, 0xffff0000, v49
    v_add_f32 v204, v204, v208
    v_add_f32 v205, v205, v209
    v_fmac_f32 v206, v208, v208
    v_fmac_f32 v207, v209, v209
    v_add_f32 v204, v204, v210
    v_add_f32 v205, v205, v211
    v_fmac_f32 v206, v210, v210
    v_fmac_f32 v207, v211, v211
    v_add_u32 v14, 0x10000, v14
    v_add_u32 v26, 0x10000, v26
    s_waitcnt lgkmcnt(0)
    v_mfma_f32_32x32x16_bf16 v[144:159], v[236:239], v[52:55], v[144:159]
    s_setprio 1
    ds_read_b128 v[56:59], v18 offset:40960
    ds_read_b64_tr_b16 v[224:225], v22 offset:57344
    ds_read_b64_tr_b16 v[226:227], v22 offset:57856
    s_add_u32 m0, s65, 139264
    s_sub_u32 s91, s91, 57216
    buffer_load_dwordx4 v3, s[28:31], s66 offen lds
    v_mfma_f32_32x32x16_bf16 v[160:175], v[52:55], v[240:243], v[160:175]
    ds_read_b64_tr_b16 v[228:229], v14
    ds_read_b64_tr_b16 v[230:231], v14 offset:1024
    s_add_u32 m0, s65, 147456
    s_add_u32 s66, s66, 172032
    buffer_load_dwordx4 v4, s[32:35], s67 offen lds
    v_mfma_f32_32x32x16_bf16 v[176:191], v[52:55], v[244:247], v[176:191]
    ds_read_b64_tr_b16 v[232:233], v26
    ds_read_b64_tr_b16 v[234:235], v26 offset:1024
    s_lshl_b32 s86, s82, 4
    s_add_u32 s86, s86, s71
    s_lshl_b32 s86, s86, 1
    s_add_u32 s86, s86, s63
    s_lshl_b32 s86, s86, 10
    s_add_u32 s101, s86, 0xd00000
    s_lshl_b32 s83, s83, 5
    s_add_u32 s83, s83, 0xf00000
    s_lshl_b32 s84, s84, 5
    s_add_u32 s84, s84, 0xf00000
    s_lshl_b32 s85, s85, 5
    s_add_u32 s85, s85, 0xf00000
    s_cmp_lg_u32 s62, 0
    s_cselect_b32 s3, 0x7ffffff0, 0
    v_mfma_f32_16x16x32_bf16 v[196:199], v[28:31], v[240:243], v[196:199]
    v_lshlrev_b32 v208, 16, v50
    v_and_b32 v209, 0xffff0000, v50
    v_lshlrev_b32 v210, 16, v51
    v_and_b32 v211, 0xffff0000, v51
    v_add_f32 v204, v204, v208
    v_add_f32 v205, v205, v209
    v_fmac_f32 v206, v208, v208
    v_fmac_f32 v207, v209, v209
    v_add_f32 v204, v204, v210
    v_add_f32 v205, v205, v211
    v_fmac_f32 v206, v210, v210
    v_fmac_f32 v207, v211, v211
    v_add_u32 v15, 0x10000, v15
    v_add_u32 v27, 0x10000, v27
    s_waitcnt lgkmcnt(0)
    v_mfma_f32_32x32x16_bf16 v[144:159], v[224:227], v[56:59], v[144:159]
    s_setprio 0
    ds_read_b128 v[60:63], v19 offset:40960
    ds_read_b64_tr_b16 v[236:237], v23 offset:57344
    ds_read_b64_tr_b16 v[238:239], v23 offset:57856
    s_add_u32 m0, s65, 155648
    s_add_u32 s67, s67, 86016
    buffer_load_dwordx4 v4, s[32:35], s67 offen lds
    v_mfma_f32_32x32x16_bf16 v[160:175], v[56:59], v[228:231], v[160:175]
    ds_read_b64_tr_b16 v[240:241], v15
    ds_read_b64_tr_b16 v[242:243], v15 offset:1024
    v_mfma_f32_32x32x16_bf16 v[176:191], v[56:59], v[232:235], v[176:191]
    ds_read_b64_tr_b16 v[244:245], v27
    ds_read_b64_tr_b16 v[246:247], v27 offset:1024
    v_mfma_f32_16x16x32_bf16 v[200:203], v[28:31], v[232:235], v[200:203]
    v_lshlrev_b32 v208, 16, v56
    v_and_b32 v209, 0xffff0000, v56
    v_lshlrev_b32 v210, 16, v57
    v_and_b32 v211, 0xffff0000, v57
    v_add_f32 v204, v204, v208
    v_add_f32 v205, v205, v209
    v_fmac_f32 v206, v208, v208
    v_fmac_f32 v207, v209, v209
    v_add_f32 v204, v204, v210
    v_add_f32 v205, v205, v211
    v_fmac_f32 v206, v210, v210
    v_fmac_f32 v207, v211, v211
    v_add_u32 v16, 0x14000, v16
    v_add_u32 v20, 0x18000, v20
    s_waitcnt vmcnt(5)
    s_waitcnt lgkmcnt(0)
    s_barrier
    v_mfma_f32_32x32x16_bf16 v[144:159], v[236:239], v[60:63], v[144:159]
    s_setprio 3
    ds_read_b128 v[64:67], v16
    ds_read_b64_tr_b16 v[224:225], v20
    ds_read_b64_tr_b16 v[226:227], v20 offset:512
    s_add_u32 m0, s65, 0
    s_add_u32 s67, s67, 86016
    buffer_load_dwordx4 v2, s[24:27], s91 offen lds
    v_mfma_f32_32x32x16_bf16 v[160:175], v[60:63], v[240:243], v[160:175]
    ds_read_b64_tr_b16 v[228:229], v12 offset:40960
    ds_read_b64_tr_b16 v[230:231], v12 offset:41984
    s_add_u32 m0, s65, 8192
    s_add_u32 s91, s91, 57344
    buffer_load_dwordx4 v2, s[24:27], s91 offen lds
    v_mfma_f32_32x32x16_bf16 v[176:191], v[60:63], v[244:247], v[176:191]
    ds_read_b64_tr_b16 v[232:233], v24 offset:40960
    ds_read_b64_tr_b16 v[234:235], v24 offset:41984
    v_lshlrev_b32 v208, 16, v58
    v_and_b32 v209, 0xffff0000, v58
    v_lshlrev_b32 v210, 16, v59
    v_and_b32 v211, 0xffff0000, v59
    v_add_f32 v204, v204, v208
    v_add_f32 v205, v205, v209
    v_fmac_f32 v206, v208, v208
    v_fmac_f32 v207, v209, v209
    v_add_f32 v204, v204, v210
    v_add_f32 v205, v205, v211
    v_fmac_f32 v206, v210, v210
    v_fmac_f32 v207, v211, v211
    v_add_u32 v17, 0x14000, v17
    v_add_u32 v21, 0x18000, v21
    s_waitcnt lgkmcnt(0)
    v_mfma_f32_32x32x16_bf16 v[144:159], v[224:227], v[64:67], v[144:159]
    s_setprio 2
    ds_read_b128 v[68:71], v17
    ds_read_b64_tr_b16 v[236:237], v21
    ds_read_b64_tr_b16 v[238:239], v21 offset:512
    s_add_u32 m0, s65, 16384
    s_sub_u32 s91, s91, 57216
    buffer_load_dwordx4 v3, s[28:31], s66 offen lds
    v_mfma_f32_32x32x16_bf16 v[160:175], v[64:67], v[228:231], v[160:175]
    ds_read_b64_tr_b16 v[240:241], v13 offset:40960
    ds_read_b64_tr_b16 v[242:243], v13 offset:41984
    s_sub_u32 s86, s2, 64
    s_cmp_lt_u32 s86, 64
    s_cbranch_scc0 L_Z16
    s_lshl_b32 s86, s86, 2
    s_lshl_b32 s87, s63, 1
    s_add_u32 s86, s86, s87
    s_add_u32 s86, s86, s79
    s_mul_i32 s86, s86, 7168
    s_add_u32 s86, s86, 1536
    v_and_b32 v217, 15, v0
    v_lshlrev_b32 v217, 7, v217
    v_bfe_u32 v218, v0, 4, 1
    v_mul_u32_u24 v218, 3584, v218
    v_add_u32 v217, v217, v218
    buffer_load_dword v216, v217, s[36:39], s86 offen
L_Z16:
    v_mfma_f32_32x32x16_bf16 v[176:191], v[64:67], v[232:235], v[176:191]
    ds_read_b64_tr_b16 v[244:245], v25 offset:40960
    ds_read_b64_tr_b16 v[246:247], v25 offset:41984
    v_mfma_f32_16x16x32_bf16 v[192:195], v[28:31], v[224:227], v[192:195]
    v_lshlrev_b32 v208, 16, v64
    v_and_b32 v209, 0xffff0000, v64
    v_lshlrev_b32 v210, 16, v65
    v_and_b32 v211, 0xffff0000, v65
    v_add_f32 v204, v204, v208
    v_add_f32 v205, v205, v209
    v_fmac_f32 v206, v208, v208
    v_fmac_f32 v207, v209, v209
    v_add_f32 v204, v204, v210
    v_add_f32 v205, v205, v211
    v_fmac_f32 v206, v210, v210
    v_fmac_f32 v207, v211, v211
    v_add_u32 v18, 0x14000, v18
    v_add_u32 v22, 0x18000, v22
    s_waitcnt lgkmcnt(0)
    v_mfma_f32_32x32x16_bf16 v[144:159], v[236:239], v[68:71], v[144:159]
    s_setprio 1
    ds_read_b128 v[72:75], v18
    ds_read_b64_tr_b16 v[224:225], v22
    ds_read_b64_tr_b16 v[226:227], v22 offset:512
    s_add_u32 m0, s65, 24576
    s_add_u32 s66, s66, 172032
    buffer_load_dwordx4 v4, s[32:35], s67 offen lds
    v_mfma_f32_32x32x16_bf16 v[160:175], v[68:71], v[240:243], v[160:175]
    ds_read_b64_tr_b16 v[228:229], v14 offset:40960
    ds_read_b64_tr_b16 v[230:231], v14 offset:41984
    s_add_u32 m0, s65, 32768
    s_add_u32 s67, s67, 86016
    buffer_load_dwordx4 v4, s[32:35], s67 offen lds
    v_mfma_f32_32x32x16_bf16 v[176:191], v[68:71], v[244:247], v[176:191]
    ds_read_b64_tr_b16 v[232:233], v26 offset:40960
    ds_read_b64_tr_b16 v[234:235], v26 offset:41984
    v_mfma_f32_16x16x32_bf16 v[196:199], v[28:31], v[240:243], v[196:199]
    v_lshlrev_b32 v208, 16, v66
    v_and_b32 v209, 0xffff0000, v66
    v_lshlrev_b32 v210, 16, v67
    v_and_b32 v211, 0xffff0000, v67
    v_add_f32 v204, v204, v208
    v_add_f32 v205, v205, v209
    v_fmac_f32 v206, v208, v208
    v_fmac_f32 v207, v209, v209
    v_add_f32 v204, v204, v210
    v_add_f32 v205, v205, v211
    v_fmac_f32 v206, v210, v210
    v_fmac_f32 v207, v211, v211
    v_add_u32 v19, 0x14000, v19
    v_add_u32 v23, 0x18000, v23
    s_waitcnt lgkmcnt(0)
    v_mfma_f32_32x32x16_bf16 v[144:159], v[224:227], v[72:75], v[144:159]
    s_setprio 0
    ds_read_b128 v[76:79], v19
    ds_read_b64_tr_b16 v[236:237], v23
    ds_read_b64_tr_b16 v[238:239], v23 offset:512
    s_add_u32 m0, s65, 40960
    s_add_u32 s67, s67, 86016
    buffer_load_dwordx4 v2, s[24:27], s91 offen lds
    v_mfma_f32_32x32x16_bf16 v[160:175], v[72:75], v[228:231], v[160:175]
    ds_read_b64_tr_b16 v[240:241], v15 offset:40960
    ds_read_b64_tr_b16 v[242:243], v15 offset:41984
    v_mfma_f32_32x32x16_bf16 v[176:191], v[72:75], v[232:235], v[176:191]
    ds_read_b64_tr_b16 v[244:245], v27 offset:40960
    ds_read_b64_tr_b16 v[246:247], v27 offset:41984
    v_mfma_f32_16x16x32_bf16 v[200:203], v[28:31], v[232:235], v[200:203]
    v_lshlrev_b32 v208, 16, v72
    v_and_b32 v209, 0xffff0000, v72
    v_lshlrev_b32 v210, 16, v73
    v_and_b32 v211, 0xffff0000, v73
    v_add_f32 v204, v204, v208
    v_add_f32 v205, v205, v209
    v_fmac_f32 v206, v208, v208
    v_fmac_f32 v207, v209, v209
    v_add_f32 v204, v204, v210
    v_add_f32 v205, v205, v211
    v_fmac_f32 v206, v210, v210
    v_fmac_f32 v207, v211, v211
    v_add_u32 v12, 0x14000, v12
    v_add_u32 v24, 0x14000, v24
    s_waitcnt vmcnt(6)
    s_waitcnt lgkmcnt(0)
    s_barrier
    s_or_b32 s86, s9, s3
    s_cmp_lt_u32 s86, 256
    s_cbranch_scc0 L_G17
    buffer_store_dword v248, v7, s[56:59], s9 offen sc1
L_G17:
    v_mfma_f32_32x32x16_bf16 v[144:159], v[236:239], v[76:79], v[144:159]
    s_setprio 3
    ds_read_b128 v[80:83], v16 offset:40960
    ds_read_b64_tr_b16 v[224:225], v20 offset:40960
    ds_read_b64_tr_b16 v[226:227], v20 offset:41472
    s_add_u32 m0, s65, 49152
    s_add_u32 s91, s91, 57344
    buffer_load_dwordx4 v2, s[24:27], s91 offen lds
    v_mfma_f32_32x32x16_bf16 v[160:175], v[76:79], v[240:243], v[160:175]
    ds_read_b64_tr_b16 v[228:229], v12
    ds_read_b64_tr_b16 v[230:231], v12 offset:1024
    s_add_u32 m0, s65, 57344
    s_sub_u32 s91, s91, 57216
    buffer_load_dwordx4 v3, s[28:31], s66 offen lds
    v_mfma_f32_32x32x16_bf16 v[176:191], v[76:79], v[244:247], v[176:191]
    ds_read_b64_tr_b16 v[232:233], v24
    ds_read_b64_tr_b16 v[234:235], v24 offset:1024
    v_lshlrev_b32 v208, 16, v74
    v_and_b32 v209, 0xffff0000, v74
    v_lshlrev_b32 v210, 16, v75
    v_and_b32 v211, 0xffff0000, v75
    v_add_f32 v204, v204, v208
    v_add_f32 v205, v205, v209
    v_fmac_f32 v206, v208, v208
    v_fmac_f32 v207, v209, v209
    v_add_f32 v204, v204, v210
    v_add_f32 v205, v205, v211
    v_fmac_f32 v206, v210, v210
    v_fmac_f32 v207, v211, v211
    v_add_u32 v13, 0x14000, v13
    v_add_u32 v25, 0x14000, v25
    s_waitcnt lgkmcnt(0)
    v_mfma_f32_32x32x16_bf16 v[144:159], v[224:227], v[80:83], v[144:159]
    s_setprio 2
    ds_read_b128 v[84:87], v17 offset:40960
    ds_read_b64_tr_b16 v[236:237], v21 offset:40960
    ds_read_b64_tr_b16 v[238:239], v21 offset:41472
    s_add_u32 m0, s65, 65536
    s_add_u32 s66, s66, 172032
    buffer_load_dwordx4 v4, s[32:35], s67 offen lds
    v_mfma_f32_32x32x16_bf16 v[160:175], v[80:83], v[228:231], v[160:175]
    ds_read_b64_tr_b16 v[240:241], v13
    ds_read_b64_tr_b16 v[242:243], v13 offset:1024
    v_mfma_f32_32x32x16_bf16 v[176:191], v[80:83], v[232:235], v[176:191]
    ds_read_b64_tr_b16 v[244:245], v25
    ds_read_b64_tr_b16 v[246:247], v25 offset:1024
    v_mfma_f32_16x16x32_bf16 v[192:195], v[28:31], v[224:227], v[192:195]
    v_lshlrev_b32 v208, 16, v80
    v_and_b32 v209, 0xffff0000, v80
    v_lshlrev_b32 v210, 16, v81
    v_and_b32 v211, 0xffff0000, v81
    v_add_f32 v204, v204, v208
    v_add_f32 v205, v205, v209
    v_fmac_f32 v206, v208, v208
    v_fmac_f32 v207, v209, v209
    v_add_f32 v204, v204, v210
    v_add_f32 v205, v205, v211
    v_fmac_f32 v206, v210, v210
    v_fmac_f32 v207, v211, v211
    v_add_u32 v14, 0x14000, v14
    v_add_u32 v26, 0x14000, v26
    s_waitcnt lgkmcnt(0)
    v_mfma_f32_32x32x16_bf16 v[144:159], v[236:239], v[84:87], v[144:159]
    s_setprio 1
    ds_read_b128 v[88:91], v18 offset:40960
    ds_read_b64_tr_b16 v[224:225], v22 offset:40960
    ds_read_b64_tr_b16 v[226:227], v22 offset:41472
    s_add_u32 m0, s65, 73728
    s_add_u32 s67, s67, 86016
    buffer_load_dwordx4 v4, s[32:35], s67 offen lds
    v_mfma_f32_32x32x16_bf16 v[160:175], v[84:87], v[240:243], v[160:175]
    ds_read_b64_tr_b16 v[228:229], v14
    ds_read_b64_tr_b16 v[230:231], v14 offset:1024
    s_add_u32 m0, s65, 81920
    s_add_u32 s67, s67, 86016
    buffer_load_dwordx4 v2, s[24:27], s91 offen lds
    v_mfma_f32_32x32x16_bf16 v[176:191], v[84:87], v[244:247], v[176:191]
    ds_read_b64_tr_b16 v[232:233], v26
    ds_read_b64_tr_b16 v[234:235], v26 offset:1024
    v_mfma_f32_16x16x32_bf16 v[196:199], v[28:31], v[240:243], v[196:199]
    v_lshlrev_b32 v208, 16, v82
    v_and_b32 v209, 0xffff0000, v82
    v_lshlrev_b32 v210, 16, v83
    v_and_b32 v211, 0xffff0000, v83
    v_add_f32 v204, v204, v208
    v_add_f32 v205, v205, v209
    v_fmac_f32 v206, v208, v208
    v_fmac_f32 v207, v209, v209
    v_add_f32 v204, v204, v210
    v_add_f32 v205, v205, v211
    v_fmac_f32 v206, v210, v210
    v_fmac_f32 v207, v211, v211
    v_add_u32 v15, 0x14000, v15
    v_add_u32 v27, 0x14000, v27
    s_waitcnt lgkmcnt(0)
    v_mfma_f32_32x32x16_bf16 v[144:159], v[224:227], v[88:91], v[144:159]
    s_setprio 0
    ds_read_b128 v[92:95], v19 offset:40960
    ds_read_b64_tr_b16 v[236:237], v23 offset:40960
    ds_read_b64_tr_b16 v[238:239], v23 offset:41472
    s_add_u32 m0, s65, 90112
    s_add_u32 s91, s91, 57344
    buffer_load_dwordx4 v2, s[24:27], s91 offen lds
    v_mfma_f32_32x32x16_bf16 v[160:175], v[88:91], v[228:231], v[160:175]
    ds_read_b64_tr_b16 v[240:241], v15
    ds_read_b64_tr_b16 v[242:243], v15 offset:1024
    v_mfma_f32_32x32x16_bf16 v[176:191], v[88:91], v[232:235], v[176:191]
    ds_read_b64_tr_b16 v[244:245], v27
    ds_read_b64_tr_b16 v[246:247], v27 offset:1024
    v_mfma_f32_16x16x32_bf16 v[200:203], v[28:31], v[232:235], v[200:203]
    v_lshlrev_b32 v208, 16, v88
    v_and_b32 v209, 0xffff0000, v88
    v_lshlrev_b32 v210, 16, v89
    v_and_b32 v211, 0xffff0000, v89
    v_add_f32 v204, v204, v208
    v_add_f32 v205, v205, v209
    v_fmac_f32 v206, v208, v208
    v_fmac_f32 v207, v209, v209
    v_add_f32 v204, v204, v210
    v_add_f32 v205, v205, v211
    v_fmac_f32 v206, v210, v210
    v_fmac_f32 v207, v211, v211
    v_add_u32 v16, 0xfffec000, v16
    v_add_u32 v20, 0xfffec000, v20
    v_add_u32 v12, 0xfffe2000, v12
    v_add_u32 v24, 0xfffe2000, v24
    s_waitcnt vmcnt(7)
    s_waitcnt lgkmcnt(0)
    s_barrier
    v_mfma_f32_32x32x16_bf16 v[144:159], v[236:239], v[92:95], v[144:159]
    s_setprio 3
    ds_read_b128 v[96:99], v16
    ds_read_b64_tr_b16 v[224:225], v20
    ds_read_b64_tr_b16 v[226:227], v20 offset:512
    s_add_u32 m0, s65, 98304
    s_sub_u32 s91, s91, 57216
    buffer_load_dwordx4 v3, s[28:31], s66 offen lds
    v_mfma_f32_32x32x16_bf16 v[160:175], v[92:95], v[240:243], v[160:175]
    ds_read_b64_tr_b16 v[228:229], v12
    ds_read_b64_tr_b16 v[230:231], v12 offset:1024
    s_add_u32 m0, s65, 106496
    s_add_u32 s66, s66, 172032
    buffer_load_dwordx4 v4, s[32:35], s67 offen lds
    v_mfma_f32_32x32x16_bf16 v[176:191], v[92:95], v[244:247], v[176:191]
    ds_read_b64_tr_b16 v[232:233], v24
    ds_read_b64_tr_b16 v[234:235], v24 offset:1024
    v_lshlrev_b32 v208, 16, v90
    v_and_b32 v209, 0xffff0000, v90
    v_lshlrev_b32 v210, 16, v91
    v_and_b32 v211, 0xffff0000, v91
    v_add_f32 v204, v204, v208
    v_add_f32 v205, v205, v209
    v_fmac_f32 v206, v208, v208
    v_fmac_f32 v207, v209, v209
    v_add_f32 v204, v204, v210
    v_add_f32 v205, v205, v211
    v_fmac_f32 v206, v210, v210
    v_fmac_f32 v207, v211, v211
    v_add_u32 v17, 0xfffec000, v17
    v_add_u32 v21, 0xfffec000, v21
    v_add_u32 v13, 0xfffe2000, v13
    v_add_u32 v25, 0xfffe2000, v25
    s_waitcnt lgkmcnt(0)
    v_mfma_f32_32x32x16_bf16 v[144:159], v[224:227], v[96:99], v[144:159]
    s_setprio 2
    ds_read_b128 v[100:103], v17
    ds_read_b64_tr_b16 v[236:237], v21
    ds_read_b64_tr_b16 v[238:239], v21 offset:512
    s_add_u32 m0, s65, 114688
    s_add_u32 s67, s67, 86016
    buffer_load_dwordx4 v4, s[32:35], s67 offen lds
    v_mfma_f32_32x32x16_bf16 v[160:175], v[96:99], v[228:231], v[160:175]
    ds_read_b64_tr_b16 v[240:241], v13
    ds_read_b64_tr_b16 v[242:243], v13 offset:1024
    s_sub_u32 s86, s2, 0
    s_cmp_lt_u32 s86, 64
    s_cbranch_scc0 L_Z18
    s_lshl_b32 s86, s86, 3
    s_add_u32 s86, s86, s62
    s_mul_i32 s87, s86, 3200
    v_min_u32 v217, 24, v0
    v_lshlrev_b32 v217, 7, v217
    buffer_load_dword v216, v217, s[44:47], s87 offen
    s_mul_i32 s87, s86, 896
    v_min_u32 v217, 0x300, v217
    buffer_load_dword v216, v217, s[48:51], s87 offen
L_Z18:
    v_mfma_f32_32x32x16_bf16 v[176:191], v[96:99], v[232:235], v[176:191]
    ds_read_b64_tr_b16 v[244:245], v25
    ds_read_b64_tr_b16 v[246:247], v25 offset:1024
    v_mfma_f32_16x16x32_bf16 v[192:195], v[28:31], v[224:227], v[192:195]
    v_lshlrev_b32 v208, 16, v96
    v_and_b32 v209, 0xffff0000, v96
    v_lshlrev_b32 v210, 16, v97
    v_and_b32 v211, 0xffff0000, v97
    v_add_f32 v204, v204, v208
    v_add_f32 v205, v205, v209
    v_fmac_f32 v206, v208, v208
    v_fmac_f32 v207, v209, v209
    v_add_f32 v204, v204, v210
    v_add_f32 v205, v205, v211
    v_fmac_f32 v206, v210, v210
    v_fmac_f32 v207, v211, v211
    v_add_u32 v18, 0xfffec000, v18
    v_add_u32 v22, 0xfffec000, v22
    v_add_u32 v14, 0xfffe2000, v14
    v_add_u32 v26, 0xfffe2000, v26
    s_waitcnt lgkmcnt(0)
    v_mfma_f32_32x32x16_bf16 v[144:159], v[236:239], v[100:103], v[144:159]
    s_setprio 1
    ds_read_b128 v[104:107], v18
    ds_read_b64_tr_b16 v[224:225], v22
    ds_read_b64_tr_b16 v[226:227], v22 offset:512
    s_add_u32 m0, s65, 122880
    s_add_u32 s67, s67, 86016
    buffer_load_dwordx4 v251, s[36:39], s69 offen lds
    v_mfma_f32_32x32x16_bf16 v[160:175], v[100:103], v[240:243], v[160:175]
    ds_read_b64_tr_b16 v[228:229], v14
    ds_read_b64_tr_b16 v[230:231], v14 offset:1024
    s_add_u32 m0, s65, 131072
    s_add_u32 s69, s69, 114688
    buffer_load_dwordx4 v251, s[36:39], s69 offen lds
    v_mfma_f32_32x32x16_bf16 v[176:191], v[100:103], v[244:247], v[176:191]
    ds_read_b64_tr_b16 v[232:233], v26
    ds_read_b64_tr_b16 v[234:235], v26 offset:1024
    v_mfma_f32_16x16x32_bf16 v[196:199], v[28:31], v[240:243], v[196:199]
    v_lshlrev_b32 v208, 16, v98
    v_and_b32 v209, 0xffff0000, v98
    v_lshlrev_b32 v210, 16, v99
    v_and_b32 v211, 0xffff0000, v99
    v_add_f32 v204, v204, v208
    v_add_f32 v205, v205, v209
    v_fmac_f32 v206, v208, v208
    v_fmac_f32 v207, v209, v209
    v_add_f32 v204, v204, v210
    v_add_f32 v205, v205, v211
    v_fmac_f32 v206, v210, v210
    v_fmac_f32 v207, v211, v211
    v_add_u32 v19, 0xfffec000, v19
    v_add_u32 v23, 0xfffec000, v23
    v_add_u32 v15, 0xfffe2000, v15
    v_add_u32 v27, 0xfffe2000, v27
    s_waitcnt lgkmcnt(0)
    v_mfma_f32_32x32x16_bf16 v[144:159], v[224:227], v[104:107], v[144:159]
    s_setprio 0
    ds_read_b128 v[108:111], v19
    ds_read_b64_tr_b16 v[236:237], v23
    ds_read_b64_tr_b16 v[238:239], v23 offset:512
    s_add_u32 m0, s65, 139264
    s_add_u32 s69, s69, 114688
    buffer_load_dwordx4 v251, s[36:39], s69 offen lds
    v_mfma_f32_32x32x16_bf16 v[160:175], v[104:107], v[228:231], v[160:175]
    ds_read_b64_tr_b16 v[240:241], v15
    ds_read_b64_tr_b16 v[242:243], v15 offset:1024
    v_mfma_f32_32x32x16_bf16 v[176:191], v[104:107], v[232:235], v[176:191]
    ds_read_b64_tr_b16 v[244:245], v27
    ds_read_b64_tr_b16 v[246:247], v27 offset:1024
    v_mfma_f32_16x16x32_bf16 v[200:203], v[28:31], v[232:235], v[200:203]
    v_lshlrev_b32 v208, 16, v104
    v_and_b32 v209, 0xffff0000, v104
    v_lshlrev_b32 v210, 16, v105
    v_and_b32 v211, 0xffff0000, v105
    v_add_f32 v204, v204, v208
    v_add_f32 v205, v205, v209
    v_fmac_f32 v206, v208, v208
    v_fmac_f32 v207, v209, v209
    v_add_f32 v204, v204, v210
    v_add_f32 v205, v205, v211
    v_fmac_f32 v206, v210, v210
    v_fmac_f32 v207, v211, v211
    s_waitcnt vmcnt(8)
    s_waitcnt lgkmcnt(0)
    s_barrier
    v_and_b32 v254, 15, v0
    v_mul_u32_u24 v254, 16, v254
    v_or_b32 v254, s3, v254
    s_cmp_eq_u32 s62, 0
    s_cbranch_scc0 L_G19
    buffer_load_dword v253, v254, s[56:59], 0 offen sc1
L_G19:
    v_mfma_f32_32x32x16_bf16 v[144:159], v[236:239], v[108:111], v[144:159]
    s_setprio 3
    ds_read_b128 v[112:115], v16 offset:40960
    ds_read_b64_tr_b16 v[224:225], v20 offset:40960
    ds_read_b64_tr_b16 v[226:227], v20 offset:41472
    s_add_u32 m0, s65, 147456
    s_add_u32 s69, s69, 114688
    buffer_load_dwordx4 v251, s[36:39], s69 offen lds
    v_mfma_f32_32x32x16_bf16 v[160:175], v[108:111], v[240:243], v[160:175]
    ds_read_b64_tr_b16 v[228:229], v12 offset:40960
    ds_read_b64_tr_b16 v[230:231], v12 offset:41984
    s_add_u32 m0, s65, 0
    s_add_u32 s69, s69, 114688
    buffer_load_dwordx4 v251, s[36:39], s69 offen lds
    v_mfma_f32_32x32x16_bf16 v[176:191], v[108:111], v[244:247], v[176:191]
    ds_read_b64_tr_b16 v[232:233], v24 offset:40960
    ds_read_b64_tr_b16 v[234:235], v24 offset:41984
    v_lshlrev_b32 v208, 16, v106
    v_and_b32 v209, 0xffff0000, v106
    v_lshlrev_b32 v210, 16, v107
    v_and_b32 v211, 0xffff0000, v107
    v_add_f32 v204, v204, v208
    v_add_f32 v205, v205, v209
    v_fmac_f32 v206, v208, v208
    v_fmac_f32 v207, v209, v209
    v_add_f32 v204, v204, v210
    v_add_f32 v205, v205, v211
    v_fmac_f32 v206, v210, v210
    v_fmac_f32 v207, v211, v211
    s_waitcnt lgkmcnt(0)
    v_mfma_f32_32x32x16_bf16 v[144:159], v[224:227], v[112:115], v[144:159]
    s_setprio 2
    ds_read_b128 v[116:119], v17 offset:40960
    ds_read_b64_tr_b16 v[236:237], v21 offset:40960
    ds_read_b64_tr_b16 v[238:239], v21 offset:41472
    s_add_u32 m0, s65, 8192
    s_add_u32 s69, s69, 114688
    buffer_load_dwordx4 v251, s[36:39], s69 offen lds
    v_mfma_f32_32x32x16_bf16 v[160:175], v[112:115], v[228:231], v[160:175]
    ds_read_b64_tr_b16 v[240:241], v13 offset:40960
    ds_read_b64_tr_b16 v[242:243], v13 offset:41984
    v_mfma_f32_32x32x16_bf16 v[176:191], v[112:115], v[232:235], v[176:191]
    ds_read_b64_tr_b16 v[244:245], v25 offset:40960
    ds_read_b64_tr_b16 v[246:247], v25 offset:41984
    v_mfma_f32_16x16x32_bf16 v[192:195], v[28:31], v[224:227], v[192:195]
    v_lshlrev_b32 v208, 16, v112
    v_and_b32 v209, 0xffff0000, v112
    v_lshlrev_b32 v210, 16, v113
    v_and_b32 v211, 0xffff0000, v113
    v_add_f32 v204, v204, v208
    v_add_f32 v205, v205, v209
    v_fmac_f32 v206, v208, v208
    v_fmac_f32 v207, v209, v209
    v_add_f32 v204, v204, v210
    v_add_f32 v205, v205, v211
    v_fmac_f32 v206, v210, v210
    v_fmac_f32 v207, v211, v211
    s_waitcnt lgkmcnt(0)
    v_mfma_f32_32x32x16_bf16 v[144:159], v[236:239], v[116:119], v[144:159]
    s_setprio 1
    ds_read_b128 v[120:123], v18 offset:40960
    ds_read_b64_tr_b16 v[224:225], v22 offset:40960
    ds_read_b64_tr_b16 v[226:227], v22 offset:41472
    s_add_u32 m0, s65, 16384
    s_add_u32 s69, s69, 114688
    buffer_load_dwordx4 v251, s[36:39], s69 offen lds
    v_mfma_f32_32x32x16_bf16 v[160:175], v[116:119], v[240:243], v[160:175]
    ds_read_b64_tr_b16 v[228:229], v14 offset:40960
    ds_read_b64_tr_b16 v[230:231], v14 offset:41984
    s_add_u32 m0, s65, 24576
    s_add_u32 s69, s69, 114688
    buffer_load_dwordx4 v251, s[36:39], s69 offen lds
    v_mfma_f32_32x32x16_bf16 v[176:191], v[116:119], v[244:247], v[176:191]
    ds_read_b64_tr_b16 v[232:233], v26 offset:40960
    ds_read_b64_tr_b16 v[234:235], v26 offset:41984
    v_mfma_f32_16x16x32_bf16 v[196:199], v[28:31], v[240:243], v[196:199]
    v_lshlrev_b32 v208, 16, v114
    v_and_b32 v209, 0xffff0000, v114
    v_lshlrev_b32 v210, 16, v115
    v_and_b32 v211, 0xffff0000, v115
    v_add_f32 v204, v204, v208
    v_add_f32 v205, v205, v209
    v_fmac_f32 v206, v208, v208
    v_fmac_f32 v207, v209, v209
    v_add_f32 v204, v204, v210
    v_add_f32 v205, v205, v211
    v_fmac_f32 v206, v210, v210
    v_fmac_f32 v207, v211, v211
    s_waitcnt lgkmcnt(0)
    v_mfma_f32_32x32x16_bf16 v[144:159], v[224:227], v[120:123], v[144:159]
    s_setprio 0
    ds_read_b128 v[124:127], v19 offset:40960
    ds_read_b64_tr_b16 v[236:237], v23 offset:40960
    ds_read_b64_tr_b16 v[238:239], v23 offset:41472
    s_add_u32 m0, s65, 32768
    s_add_u32 s69, s69, 114688
    buffer_load_dwordx4 v6, s[44:47], s74 offen lds
    v_mfma_f32_32x32x16_bf16 v[160:175], v[120:123], v[228:231], v[160:175]
    ds_read_b64_tr_b16 v[240:241], v15 offset:40960
    ds_read_b64_tr_b16 v[242:243], v15 offset:41984
    v_mfma_f32_32x32x16_bf16 v[176:191], v[120:123], v[232:235], v[176:191]
    ds_read_b64_tr_b16 v[244:245], v27 offset:40960
    ds_read_b64_tr_b16 v[246:247], v27 offset:41984
    v_mfma_f32_16x16x32_bf16 v[200:203], v[28:31], v[232:235], v[200:203]
    v_lshlrev_b32 v208, 16, v120
    v_and_b32 v209, 0xffff0000, v120
    v_lshlrev_b32 v210, 16, v121
    v_and_b32 v211, 0xffff0000, v121
    v_add_f32 v204, v204, v208
    v_add_f32 v205, v205, v209
    v_fmac_f32 v206, v208, v208
    v_fmac_f32 v207, v209, v209
    v_add_f32 v204, v204, v210
    v_add_f32 v205, v205, v211
    v_fmac_f32 v206, v210, v210
    v_fmac_f32 v207, v211, v211
    v_add_u32 v16, 0x14000, v16
    v_add_u32 v20, 0x14000, v20
    v_add_u32 v12, 0x14000, v12
    v_add_u32 v24, 0x14000, v24
    s_waitcnt vmcnt(9)
    s_cmp_lg_u32 s62, 0
    s_cbranch_scc1 L_OK20
    s_waitcnt vmcnt(6)
    s_mov_b32 s90, 100000
L_SP20:
    v_and_b32 v253, 0xff, v253
    v_cmp_ne_u32 vcc, 1, v253
    s_nop 1
    s_cbranch_vccz L_OK20
    s_sleep 4
    buffer_load_dword v253, v254, s[56:59], 0 offen sc1
    s_sub_u32 s90, s90, 1
    s_waitcnt vmcnt(0)
    s_cbranch_scc0 L_SP20
L_OK20:
    s_waitcnt lgkmcnt(0)
    s_barrier
    v_mfma_f32_32x32x16_bf16 v[144:159], v[236:239], v[124:127], v[144:159]
    s_setprio 3
    ds_read_b128 v[128:131], v16
    ds_read_b64_tr_b16 v[224:225], v20
    ds_read_b64_tr_b16 v[226:227], v20 offset:512
    s_add_u32 m0, s65, 40960
    s_add_u32 s74, s74, 14336
    buffer_load_dwordx4 v251, s[36:39], s69 offen lds
    v_mfma_f32_32x32x16_bf16 v[160:175], v[124:127], v[240:243], v[160:175]
    ds_read_b64_tr_b16 v[228:229], v12
    ds_read_b64_tr_b16 v[230:231], v12 offset:1024
    s_add_u32 m0, s65, 49152
    s_add_u32 s69, s69, 114688
    buffer_load_dwordx4 v251, s[36:39], s69 offen lds
    v_mfma_f32_32x32x16_bf16 v[176:191], v[124:127], v[244:247], v[176:191]
    ds_read_b64_tr_b16 v[232:233], v24
    ds_read_b64_tr_b16 v[234:235], v24 offset:1024
    v_lshlrev_b32 v208, 16, v122
    v_and_b32 v209, 0xffff0000, v122
    v_lshlrev_b32 v210, 16, v123
    v_and_b32 v211, 0xffff0000, v123
    v_add_f32 v204, v204, v208
    v_add_f32 v205, v205, v209
    v_fmac_f32 v206, v208, v208
    v_fmac_f32 v207, v209, v209
    v_add_f32 v204, v204, v210
    v_add_f32 v205, v205, v211
    v_fmac_f32 v206, v210, v210
    v_fmac_f32 v207, v211, v211
    v_add_u32 v17, 0x14000, v17
    v_add_u32 v21, 0x14000, v21
    v_add_u32 v13, 0x14000, v13
    v_add_u32 v25, 0x14000, v25
    s_waitcnt lgkmcnt(0)
    v_mfma_f32_32x32x16_bf16 v[144:159], v[224:227], v[128:131], v[144:159]
    s_setprio 2
    ds_read_b128 v[132:135], v17
    ds_read_b64_tr_b16 v[236:237], v21
    ds_read_b64_tr_b16 v[238:239], v21 offset:512
    s_add_u32 m0, s65, 57344
    s_add_u32 s69, s69, 114688
    buffer_load_dwordx4 v251, s[36:39], s69 offen lds
    v_mfma_f32_32x32x16_bf16 v[160:175], v[128:131], v[228:231], v[160:175]
    ds_read_b64_tr_b16 v[240:241], v13
    ds_read_b64_tr_b16 v[242:243], v13 offset:1024
    v_mfma_f32_32x32x16_bf16 v[176:191], v[128:131], v[232:235], v[176:191]
    ds_read_b64_tr_b16 v[244:245], v25
    ds_read_b64_tr_b16 v[246:247], v25 offset:1024
    v_mfma_f32_16x16x32_bf16 v[192:195], v[28:31], v[224:227], v[192:195]
    v_lshlrev_b32 v208, 16, v128
    v_and_b32 v209, 0xffff0000, v128
    v_lshlrev_b32 v210, 16, v129
    v_and_b32 v211, 0xffff0000, v129
    v_add_f32 v204, v204, v208
    v_add_f32 v205, v205, v209
    v_fmac_f32 v206, v208, v208
    v_fmac_f32 v207, v209, v209
    v_add_f32 v204, v204, v210
    v_add_f32 v205, v205, v211
    v_fmac_f32 v206, v210, v210
    v_fmac_f32 v207, v211, v211
    v_add_u32 v18, 0x14000, v18
    v_add_u32 v22, 0x14000, v22
    v_add_u32 v14, 0x14000, v14
    v_add_u32 v26, 0x14000, v26
    s_waitcnt lgkmcnt(0)
    v_mfma_f32_32x32x16_bf16 v[144:159], v[236:239], v[132:135], v[144:159]
    s_setprio 1
    ds_read_b128 v[136:139], v18
    ds_read_b64_tr_b16 v[224:225], v22
    ds_read_b64_tr_b16 v[226:227], v22 offset:512
    s_add_u32 m0, s65, 65536
    s_add_u32 s69, s69, 114688
    buffer_load_dwordx4 v251, s[36:39], s69 offen lds
    v_mfma_f32_32x32x16_bf16 v[160:175], v[132:135], v[240:243], v[160:175]
    ds_read_b64_tr_b16 v[228:229], v14
    ds_read_b64_tr_b16 v[230:231], v14 offset:1024
    s_add_u32 m0, s65, 73728
    s_add_u32 s69, s69, 114688
    buffer_load_dwordx4 v6, s[44:47], s74 offen lds
    v_mfma_f32_32x32x16_bf16 v[176:191], v[132:135], v[244:247], v[176:191]
    ds_read_b64_tr_b16 v[232:233], v26
    ds_read_b64_tr_b16 v[234:235], v26 offset:1024
    v_mfma_f32_16x16x32_bf16 v[196:199], v[28:31], v[240:243], v[196:199]
    v_lshlrev_b32 v208, 16, v130
    v_and_b32 v209, 0xffff0000, v130
    v_lshlrev_b32 v210, 16, v131
    v_and_b32 v211, 0xffff0000, v131
    v_add_f32 v204, v204, v208
    v_add_f32 v205, v205, v209
    v_fmac_f32 v206, v208, v208
    v_fmac_f32 v207, v209, v209
    v_add_f32 v204, v204, v210
    v_add_f32 v205, v205, v211
    v_fmac_f32 v206, v210, v210
    v_fmac_f32 v207, v211, v211
    v_add_u32 v19, 0x14000, v19
    v_add_u32 v23, 0x14000, v23
    v_add_u32 v15, 0x14000, v15
    v_add_u32 v27, 0x14000, v27
    s_waitcnt lgkmcnt(0)
    v_mfma_f32_32x32x16_bf16 v[144:159], v[224:227], v[136:139], v[144:159]
    s_setprio 0
    ds_read_b128 v[140:143], v19
    ds_read_b64_tr_b16 v[236:237], v23
    ds_read_b64_tr_b16 v[238:239], v23 offset:512
    v_mfma_f32_32x32x16_bf16 v[160:175], v[136:139], v[228:231], v[160:175]
    ds_read_b64_tr_b16 v[240:241], v15
    ds_read_b64_tr_b16 v[242:243], v15 offset:1024
    v_mfma_f32_32x32x16_bf16 v[176:191], v[136:139], v[232:235], v[176:191]
    ds_read_b64_tr_b16 v[244:245], v27
    ds_read_b64_tr_b16 v[246:247], v27 offset:1024
    v_mfma_f32_16x16x32_bf16 v[200:203], v[28:31], v[232:235], v[200:203]
    v_lshlrev_b32 v208, 16, v136
    v_and_b32 v209, 0xffff0000, v136
    v_lshlrev_b32 v210, 16, v137
    v_and_b32 v211, 0xffff0000, v137
    v_add_f32 v204, v204, v208
    v_add_f32 v205, v205, v209
    v_fmac_f32 v206, v208, v208
    v_fmac_f32 v207, v209, v209
    v_add_f32 v204, v204, v210
    v_add_f32 v205, v205, v211
    v_fmac_f32 v206, v210, v210
    v_fmac_f32 v207, v211, v211
    v_lshlrev_b32 v208, 16, v138
    v_and_b32 v209, 0xffff0000, v138
    v_lshlrev_b32 v210, 16, v139
    v_and_b32 v211, 0xffff0000, v139
    v_add_f32 v204, v204, v208
    v_add_f32 v205, v205, v209
    v_fmac_f32 v206, v208, v208
    v_fmac_f32 v207, v209, v209
    v_add_f32 v204, v204, v210
    v_add_f32 v205, v205, v211
    v_fmac_f32 v206, v210, v210
    v_fmac_f32 v207, v211, v211
    s_mul_i32 s86, s63, 1536
    v_add_u32 v249, s86, v249
    v_add_f32 v254, v204, v205
    v_add_f32 v255, v206, v207
    v_mov_b32 v204, v254
    v_mov_b32 v205, v255
    s_lshl_b32 s86, s63, 8
    v_add_u32 v206, s86, v250
    v_permlane32_swap_b32 v254, v204
    v_permlane32_swap_b32 v255, v205
    v_add_f32 v254, v254, v204
    v_add_f32 v255, v255, v205
    ds_write_b64 v206, v[254:255]
    ds_write_b32 v249, v192
    ds_write_b32 v249, v196 offset:512
    ds_write_b32 v249, v200 offset:1024
    v_and_b32 v249, 0xfffffff0, v249
    s_waitcnt vmcnt(8)
    s_waitcnt lgkmcnt(0)
    s_barrier
    s_lshl_b32 s86, s63, 6
    v_add_u32 v15, s86, v10
    v_xor_b32 v15, v15, v11
    v_add3_u32 v15, v15, v9, 0
    s_xor_b32 s87, s96, 0
    s_lshl_b32 s87, s87, 12
    v_add_u32 v12, s87, v15
    s_xor_b32 s87, s96, 1
    s_lshl_b32 s87, s87, 12
    v_add_u32 v13, s87, v15
    s_xor_b32 s87, s96, 2
    s_lshl_b32 s87, s87, 12
    v_add_u32 v14, s87, v15
    s_xor_b32 s87, s96, 3
    s_lshl_b32 s87, s87, 12
    v_add_u32 v15, s87, v15
    v_mfma_f32_32x32x16_bf16 v[144:159], v[236:239], v[140:143], v[144:159]
    s_setprio 3
    v_add_u32 v12, 0x1e000, v12
    ds_read_b64_tr_b16 v[224:225], v12
    ds_read_b64_tr_b16 v[226:227], v12 offset:512
    s_add_u32 m0, s65, 81920
    s_add_u32 s74, s74, 14336
    buffer_load_dwordx4 v251, s[36:39], s69 offen lds
    ds_read_b64 v[204:205], v250
    ds_read_b64 v[206:207], v250 offset:256
    ds_read_b128 v[16:19], v249
    ds_read_b128 v[20:23], v249 offset:512
    ds_read_b128 v[24:27], v249 offset:1024
    v_mfma_f32_32x32x16_bf16 v[160:175], v[140:143], v[240:243], v[160:175]
    ds_read_b64_tr_b16 v[228:229], v12 offset:2048
    ds_read_b64_tr_b16 v[230:231], v12 offset:2560
    s_add_u32 m0, s65, 90112
    s_add_u32 s69, s69, 114688
    buffer_load_dwordx4 v251, s[36:39], s69 offen lds
    v_mfma_f32_32x32x16_bf16 v[176:191], v[140:143], v[244:247], v[176:191]
    s_waitcnt lgkmcnt(5)
    v_add_f32 v204, v204, v206
    v_add_f32 v205, v205, v207
    v_mul_f32 v204, 0x3b124925, v204
    v_mul_f32 v205, 0x3b124925, v205
    v_fma_f32 v205, -v204, v204, v205
    v_cvt_pk_bf16_f32 v2, -v204, -v204
    v_max_f32 v205, 0, v205
    v_cndmask_b32 v2, v2, 0, s[92:93]
    v_cvt_pk_bf16_f32 v205, 0, v205
    v_mov_b32 v3, 0
    v_add_f32 v205, 0x3727c5ac, v205
    v_mov_b32 v4, 0
    v_cvt_pk_bf16_f32 v205, 0, v205
    v_mov_b32 v5, 0
    v_sqrt_f32 v205, v205
    s_nop 0
    v_cvt_pk_bf16_f32 v254, 0, v205
    v_rcp_f32 v8, v254
    s_waitcnt lgkmcnt(4)
    v_add_f32 v16, v16, v17
    v_add_f32 v18, v18, v19
    s_waitcnt lgkmcnt(3)
    v_add_f32 v20, v20, v21
    v_add_f32 v22, v22, v23
    s_waitcnt lgkmcnt(2)
    v_add_f32 v24, v24, v25
    v_add_f32 v26, v26, v27
    v_add_f32 v16, v16, v18
    v_mov_b32 v19, 0
    v_add_f32 v20, v20, v22
    v_mov_b32 v23, 0
    v_add_f32 v24, v24, v26
    v_mov_b32 v27, 0
    v_and_b32 v17, 0xffff0000, v16
    v_mov_b32 v18, 0
    v_and_b32 v21, 0xffff0000, v20
    v_mov_b32 v22, 0
    v_and_b32 v25, 0xffff0000, v24
    v_mov_b32 v26, 0
    v_sub_f32 v16, v16, v17
    v_sub_f32 v20, v20, v21
    v_sub_f32 v24, v24, v25
    v_cvt_pk_bf16_f32 v16, v16, v17
    v_cvt_pk_bf16_f32 v20, v20, v21
    v_cvt_pk_bf16_f32 v24, v24, v25
    v_mov_b32 v17, 0
    v_mov_b32 v21, 0
    v_mov_b32 v25, 0
    s_waitcnt lgkmcnt(0)
    v_mfma_f32_32x32x16_bf16 v[144:159], v[16:19], v[2:5], v[144:159]
    v_mfma_f32_32x32x16_bf16 v[160:175], v[2:5], v[20:23], v[160:175]
    v_mfma_f32_32x32x16_bf16 v[176:191], v[2:5], v[24:27], v[176:191]
    v_mfma_f32_32x32x16_bf16 v[192:207], v[224:227], v[32:35], 0
    v_add_u32 v13, 0x1e000, v13
    ds_read_b64_tr_b16 v[232:233], v13
    ds_read_b64_tr_b16 v[234:235], v13 offset:512
    s_add_u32 m0, s65, 98304
    s_add_u32 s69, s69, 114688
    buffer_load_dwordx4 v6, s[44:47], s74 offen lds
    v_mfma_f32_32x32x16_bf16 v[208:223], v[228:231], v[32:35], 0
    ds_read_b64_tr_b16 v[236:237], v13 offset:2048
    ds_read_b64_tr_b16 v[238:239], v13 offset:2560
    v_mfma_f32_16x16x32_bf16 v[240:243], v[28:31], v[224:227], 0
    v_mul_f32 v26, v254, v254
    v_mul_f32 v24, 0xc0135761, v8
    v_mul_f32 v25, v8, v8
    v_mul_f32 v25, 0x3d372713, v25
    v_mul_f32 v25, v25, v24
    s_lshl_b32 s88, s100, 1
    s_add_u32 s88, s88, s63
    s_and_b32 s87, s88, 15
    s_lshl_b32 s87, s87, 6
    s_add_u32 s87, s87, s70
    s_lshl_b32 s80, s87, 11
    s_lshl_b32 s87, s87, 12
    s_add_u32 s87, s87, 0x200000
    s_cmp_ge_u32 s88, 16
    s_cselect_b32 s80, s87, s80
    s_cselect_b32 s87, 1.0, 0x3e8b97f6
    s_cselect_b32 s88, 1.0, 0
    s_cselect_b32 s4, -1, -2
    v_mul_f32 v254, s87, v8
    v_mov_b32 v255, s88
    v_cndmask_b32 v255, 0, v255, s[92:93]
    v_mul_f32 v144, v144, v254
    v_mul_f32 v145, v145, v254
    v_mul_f32 v146, v146, v254
    v_mul_f32 v147, v147, v254
    v_mul_f32 v148, v148, v254
    v_add_u32 v14, 0x1e000, v14
    s_waitcnt lgkmcnt(0)
    v_mfma_f32_32x32x16_bf16 v[192:207], v[232:235], v[36:39], v[192:207]
    ds_read_b64_tr_b16 v[224:225], v14
    ds_read_b64_tr_b16 v[226:227], v14 offset:512
    s_add_u32 m0, s65, 106496
    s_add_u32 s74, s74, 14336
    buffer_load_dwordx4 v6, s[44:47], s74 offen lds
    v_mfma_f32_32x32x16_bf16 v[208:223], v[236:239], v[36:39], v[208:223]
    ds_read_b64_tr_b16 v[228:229], v14 offset:2048
    ds_read_b64_tr_b16 v[230:231], v14 offset:2560
    v_mul_f32 v149, v149, v254
    v_mul_f32 v150, v150, v254
    v_mul_f32 v151, v151, v254
    v_mul_f32 v152, v152, v254
    v_mul_f32 v153, v153, v254
    v_mul_f32 v154, v154, v254
    v_mul_f32 v155, v155, v254
    v_cndmask_b32 v254, v254, 0, s[92:93]
    v_cvt_pk_bf16_f32 v144, v144, v145
    v_cvt_pk_bf16_f32 v145, v146, v147
    v_cvt_pk_bf16_f32 v146, v148, v149
    v_cvt_pk_bf16_f32 v147, v150, v151
    v_add_u32 v15, 0x1e000, v15
    s_waitcnt lgkmcnt(0)
    v_mfma_f32_32x32x16_bf16 v[192:207], v[224:227], v[40:43], v[192:207]
    s_setprio 2
    ds_read_b64_tr_b16 v[232:233], v15
    ds_read_b64_tr_b16 v[234:235], v15 offset:512
    s_add_u32 m0, s65, 114688
    s_add_u32 s74, s74, 14336
    buffer_load_dwordx4 v6, s[44:47], s74 offen lds
    v_mfma_f32_32x32x16_bf16 v[208:223], v[228:231], v[40:43], v[208:223]
    ds_read_b64_tr_b16 v[236:237], v15 offset:2048
    ds_read_b64_tr_b16 v[238:239], v15 offset:2560
    v_mfma_f32_16x16x32_bf16 v[244:247], v[28:31], v[228:231], 0
    v_and_b32 v144, s4, v144
    buffer_store_dwordx4 v[144:147], v1, s[40:43], s80 offen sc1
    v_fma_f32 v156, v156, v254, v255
    v_mul_f32 v157, v157, v254
    v_mul_f32 v158, v158, v254
    v_mul_f32 v159, v159, v254
    v_cvt_pk_bf16_f32 v148, v152, v153
    v_cvt_pk_bf16_f32 v149, v154, v155
    v_cvt_pk_bf16_f32 v150, v156, v157
    v_cvt_pk_bf16_f32 v151, v158, v159
    v_and_b32 v148, s4, v148
    buffer_store_dwordx4 v[148:151], v1, s[40:43], s80 offen offset:1024 sc1
    s_waitcnt lgkmcnt(0)
    v_mfma_f32_32x32x16_bf16 v[192:207], v[232:235], v[44:47], v[192:207]
    ds_read_b64_tr_b16 v[224:225], v12 offset:16384
    ds_read_b64_tr_b16 v[226:227], v12 offset:16896
    v_mfma_f32_32x32x16_bf16 v[208:223], v[236:239], v[44:47], v[208:223]
    ds_read_b64_tr_b16 v[228:229], v12 offset:18432
    ds_read_b64_tr_b16 v[230:231], v12 offset:18944
    v_and_b32 v255, 31, v0
    s_lshl_b32 s87, s62, 7
    s_add_u32 s87, s87, 158720
    v_lshl_add_u32 v254, v255, 2, s87
    ds_write_b32 v254, v8
    v_lshrrev_b32 v254, 5, v0
    v_lshl_add_u32 v254, v254, 4, s87
    ds_read_b128 v[152:155], v254
    ds_read_b128 v[156:159], v254 offset:32
    ds_read_b128 v[16:19], v254 offset:64
    ds_read_b128 v[20:23], v254 offset:96
    v_cmp_gt_u32 vcc, 28, v255
    s_waitcnt lgkmcnt(0)
    v_mfma_f32_32x32x16_bf16 v[192:207], v[224:227], v[48:51], v[192:207]
    s_setprio 1
    ds_read_b64_tr_b16 v[232:233], v13 offset:16384
    ds_read_b64_tr_b16 v[234:235], v13 offset:16896
    v_mfma_f32_32x32x16_bf16 v[208:223], v[228:231], v[48:51], v[208:223]
    ds_read_b64_tr_b16 v[236:237], v13 offset:18432
    ds_read_b64_tr_b16 v[238:239], v13 offset:18944
    v_mfma_f32_16x16x32_bf16 v[240:243], v[28:31], v[224:227], v[240:243]
    v_mov_b32 v254, 0x4b800000
    v_cndmask_b32 v254, 0, v254, vcc
    v_cmp_eq_u32 vcc, 28, v255
    s_nop 1
    v_cndmask_b32 v255, 0, 1.0, vcc
    s_lshl_b32 s80, s97, 1
    s_add_u32 s80, s80, s63
    s_lshl_b32 s80, s80, 7
    s_add_u32 s80, s80, s70
    s_lshl_b32 s80, s80, 12
    s_add_u32 s80, s80, 0x200000
    v_mul_f32 v152, v152, v254
    v_mul_f32 v153, v153, v254
    s_waitcnt lgkmcnt(0)
    v_mfma_f32_32x32x16_bf16 v[192:207], v[232:235], v[52:55], v[192:207]
    ds_read_b64_tr_b16 v[224:225], v14 offset:16384
    ds_read_b64_tr_b16 v[226:227], v14 offset:16896
    v_mfma_f32_32x32x16_bf16 v[208:223], v[236:239], v[52:55], v[208:223]
    ds_read_b64_tr_b16 v[228:229], v14 offset:18432
    ds_read_b64_tr_b16 v[230:231], v14 offset:18944
    v_mul_f32 v154, v154, v254
    v_mul_f32 v155, v155, v254
    v_mul_f32 v156, v156, v254
    v_mul_f32 v157, v157, v254
    v_mul_f32 v158, v158, v254
    v_mul_f32 v159, v159, v254
    v_mul_f32 v16, v16, v254
    v_mul_f32 v17, v17, v254
    v_mul_f32 v18, v18, v254
    v_mul_f32 v19, v19, v254
    v_mul_f32 v20, v20, v254
    v_mul_f32 v21, v21, v254
    s_waitcnt lgkmcnt(0)
    v_mfma_f32_32x32x16_bf16 v[192:207], v[224:227], v[56:59], v[192:207]
    s_setprio 0
    ds_read_b64_tr_b16 v[232:233], v15 offset:16384
    ds_read_b64_tr_b16 v[234:235], v15 offset:16896
    v_mfma_f32_32x32x16_bf16 v[208:223], v[228:231], v[56:59], v[208:223]
    ds_read_b64_tr_b16 v[236:237], v15 offset:18432
    ds_read_b64_tr_b16 v[238:239], v15 offset:18944
    v_mfma_f32_16x16x32_bf16 v[244:247], v[28:31], v[228:231], v[244:247]
    v_mul_f32 v22, v22, v254
    v_mul_f32 v23, v23, v254
    v_fma_f32 v160, v160, v152, v255
    v_fma_f32 v161, v161, v153, v255
    v_fma_f32 v162, v162, v154, v255
    v_fma_f32 v163, v163, v155, v255
    v_fma_f32 v164, v164, v156, v255
    v_fma_f32 v165, v165, v157, v255
    v_fma_f32 v166, v166, v158, v255
    v_fma_f32 v167, v167, v159, v255
    v_cvt_pk_bf16_f32 v160, v160, v161
    v_cvt_pk_bf16_f32 v161, v162, v163
    v_add_u32 v12, 0xfffe2000, v12
    s_waitcnt lgkmcnt(0)
    v_mfma_f32_32x32x16_bf16 v[192:207], v[232:235], v[60:63], v[192:207]
    ds_read_b64_tr_b16 v[224:225], v12
    ds_read_b64_tr_b16 v[226:227], v12 offset:512
    v_mfma_f32_32x32x16_bf16 v[208:223], v[236:239], v[60:63], v[208:223]
    ds_read_b64_tr_b16 v[228:229], v12 offset:2048
    ds_read_b64_tr_b16 v[230:231], v12 offset:2560
    v_cvt_pk_bf16_f32 v162, v164, v165
    v_cvt_pk_bf16_f32 v163, v166, v167
    buffer_store_dwordx4 v[160:163], v1, s[40:43], s80 offen offset:2048 sc1
    v_fma_f32 v168, v168, v16, v255
    v_fma_f32 v169, v169, v17, v255
    v_fma_f32 v170, v170, v18, v255
    v_fma_f32 v171, v171, v19, v255
    v_fma_f32 v172, v172, v20, v255
    v_fma_f32 v173, v173, v21, v255
    v_fma_f32 v174, v174, v22, v255
    v_fma_f32 v175, v175, v23, v255
    v_cvt_pk_bf16_f32 v168, v168, v169
    v_add_u32 v13, 0xfffe2000, v13
    s_waitcnt vmcnt(11)
    s_waitcnt lgkmcnt(0)
    s_barrier
    v_mfma_f32_32x32x16_bf16 v[192:207], v[224:227], v[64:67], v[192:207]
    s_setprio 3
    ds_read_b64_tr_b16 v[232:233], v13
    ds_read_b64_tr_b16 v[234:235], v13 offset:512
    v_mfma_f32_32x32x16_bf16 v[208:223], v[228:231], v[64:67], v[208:223]
    ds_read_b64_tr_b16 v[236:237], v13 offset:2048
    ds_read_b64_tr_b16 v[238:239], v13 offset:2560
    v_mfma_f32_16x16x32_bf16 v[240:243], v[28:31], v[224:227], v[240:243]
    v_cvt_pk_bf16_f32 v169, v170, v171
    v_cvt_pk_bf16_f32 v170, v172, v173
    v_cvt_pk_bf16_f32 v171, v174, v175
    buffer_store_dwordx4 v[168:171], v1, s[40:43], s80 offen offset:3072 sc1
    s_add_u32 s80, s80, 262144
    v_fma_f32 v176, v176, v152, v255
    v_fma_f32 v177, v177, v153, v255
    v_fma_f32 v178, v178, v154, v255
    v_fma_f32 v179, v179, v155, v255
    v_fma_f32 v180, v180, v156, v255
    v_fma_f32 v181, v181, v157, v255
    v_fma_f32 v182, v182, v158, v255
    v_add_u32 v14, 0xfffe2000, v14
    s_waitcnt lgkmcnt(0)
    v_mfma_f32_32x32x16_bf16 v[192:207], v[232:235], v[68:71], v[192:207]
    ds_read_b64_tr_b16 v[224:225], v14
    ds_read_b64_tr_b16 v[226:227], v14 offset:512
    v_mfma_f32_32x32x16_bf16 v[208:223], v[236:239], v[68:71], v[208:223]
    ds_read_b64_tr_b16 v[228:229], v14 offset:2048
    ds_read_b64_tr_b16 v[230:231], v14 offset:2560
    v_fma_f32 v183, v183, v159, v255
    v_cvt_pk_bf16_f32 v176, v176, v177
    v_cvt_pk_bf16_f32 v177, v178, v179
    v_cvt_pk_bf16_f32 v178, v180, v181
    v_cvt_pk_bf16_f32 v179, v182, v183
    buffer_store_dwordx4 v[176:179], v1, s[40:43], s80 offen offset:2048 sc1
    v_fma_f32 v184, v184, v16, v255
    v_fma_f32 v185, v185, v17, v255
    v_fma_f32 v186, v186, v18, v255
    v_fma_f32 v187, v187, v19, v255
    v_fma_f32 v188, v188, v20, v255
    v_fma_f32 v189, v189, v21, v255
    v_add_u32 v15, 0xfffe2000, v15
    s_waitcnt lgkmcnt(0)
    v_mfma_f32_32x32x16_bf16 v[192:207], v[224:227], v[72:75], v[192:207]
    ds_read_b64_tr_b16 v[232:233], v15
    ds_read_b64_tr_b16 v[234:235], v15 offset:512
    v_mfma_f32_32x32x16_bf16 v[208:223], v[228:231], v[72:75], v[208:223]
    ds_read_b64_tr_b16 v[236:237], v15 offset:2048
    ds_read_b64_tr_b16 v[238:239], v15 offset:2560
    v_mfma_f32_16x16x32_bf16 v[244:247], v[28:31], v[228:231], v[244:247]
    v_fma_f32 v190, v190, v22, v255
    v_fma_f32 v191, v191, v23, v255
    v_cvt_pk_bf16_f32 v184, v184, v185
    v_cvt_pk_bf16_f32 v185, v186, v187
    v_cvt_pk_bf16_f32 v186, v188, v189
    v_cvt_pk_bf16_f32 v187, v190, v191
    buffer_store_dwordx4 v[184:187], v1, s[40:43], s80 offen offset:3072 sc1
    s_add_u32 s80, s80, 262144
    s_waitcnt lgkmcnt(0)
    v_mfma_f32_32x32x16_bf16 v[192:207], v[232:235], v[76:79], v[192:207]
    s_setprio 2
    ds_read_b64_tr_b16 v[224:225], v12 offset:16384
    ds_read_b64_tr_b16 v[226:227], v12 offset:16896
    v_mfma_f32_32x32x16_bf16 v[208:223], v[236:239], v[76:79], v[208:223]
    ds_read_b64_tr_b16 v[228:229], v12 offset:18432
    ds_read_b64_tr_b16 v[230:231], v12 offset:18944
    s_waitcnt lgkmcnt(0)
    v_mfma_f32_32x32x16_bf16 v[192:207], v[224:227], v[80:83], v[192:207]
    ds_read_b64_tr_b16 v[232:233], v13 offset:16384
    ds_read_b64_tr_b16 v[234:235], v13 offset:16896
    v_mfma_f32_32x32x16_bf16 v[208:223], v[228:231], v[80:83], v[208:223]
    ds_read_b64_tr_b16 v[236:237], v13 offset:18432
    ds_read_b64_tr_b16 v[238:239], v13 offset:18944
    v_mfma_f32_16x16x32_bf16 v[240:243], v[28:31], v[224:227], v[240:243]
    s_waitcnt lgkmcnt(0)
    v_mfma_f32_32x32x16_bf16 v[192:207], v[232:235], v[84:87], v[192:207]
    s_setprio 1
    ds_read_b64_tr_b16 v[224:225], v14 offset:16384
    ds_read_b64_tr_b16 v[226:227], v14 offset:16896
    v_mfma_f32_32x32x16_bf16 v[208:223], v[236:239], v[84:87], v[208:223]
    ds_read_b64_tr_b16 v[228:229], v14 offset:18432
    ds_read_b64_tr_b16 v[230:231], v14 offset:18944
    s_waitcnt lgkmcnt(0)
    v_mfma_f32_32x32x16_bf16 v[192:207], v[224:227], v[88:91], v[192:207]
    ds_read_b64_tr_b16 v[232:233], v15 offset:16384
    ds_read_b64_tr_b16 v[234:235], v15 offset:16896
    v_mfma_f32_32x32x16_bf16 v[208:223], v[228:231], v[88:91], v[208:223]
    ds_read_b64_tr_b16 v[236:237], v15 offset:18432
    ds_read_b64_tr_b16 v[238:239], v15 offset:18944
    v_mfma_f32_16x16x32_bf16 v[244:247], v[28:31], v[228:231], v[244:247]
    s_waitcnt lgkmcnt(0)
    v_mfma_f32_32x32x16_bf16 v[192:207], v[232:235], v[92:95], v[192:207]
    ds_read_b64_tr_b16 v[224:225], v12 offset:40960
    ds_read_b64_tr_b16 v[226:227], v12 offset:41472
    v_mfma_f32_32x32x16_bf16 v[208:223], v[236:239], v[92:95], v[208:223]
    ds_read_b64_tr_b16 v[228:229], v12 offset:43008
    ds_read_b64_tr_b16 v[230:231], v12 offset:43520
    s_waitcnt lgkmcnt(0)
    v_mfma_f32_32x32x16_bf16 v[192:207], v[224:227], v[96:99], v[192:207]
    s_setprio 0
    ds_read_b64_tr_b16 v[232:233], v13 offset:40960
    ds_read_b64_tr_b16 v[234:235], v13 offset:41472
    v_mfma_f32_32x32x16_bf16 v[208:223], v[228:231], v[96:99], v[208:223]
    ds_read_b64_tr_b16 v[236:237], v13 offset:43008
    ds_read_b64_tr_b16 v[238:239], v13 offset:43520
    v_mfma_f32_16x16x32_bf16 v[240:243], v[28:31], v[224:227], v[240:243]
    s_waitcnt lgkmcnt(0)
    v_mfma_f32_32x32x16_bf16 v[192:207], v[232:235], v[100:103], v[192:207]
    ds_read_b64_tr_b16 v[224:225], v14 offset:40960
    ds_read_b64_tr_b16 v[226:227], v14 offset:41472
    v_mfma_f32_32x32x16_bf16 v[208:223], v[236:239], v[100:103], v[208:223]
    ds_read_b64_tr_b16 v[228:229], v14 offset:43008
    ds_read_b64_tr_b16 v[230:231], v14 offset:43520
    s_waitcnt vmcnt(0)
    s_waitcnt lgkmcnt(0)
    s_barrier
    s_cmp_eq_u32 s62, 0
    s_cbranch_scc0 L_G21
    buffer_store_dword v248, v7, s[40:43], s83 offen sc1
    buffer_store_dword v248, v7, s[40:43], s84 offen sc1
L_G21:
    s_lshr_b32 s86, s71, 1
    s_lshl_b32 s86, s86, 6
    s_lshl_b32 s87, s72, 2
    s_add_u32 s87, s87, s86
    s_add_u32 s86, s86, 512
    s_lshr_b32 s88, s71, 2
    s_lshl_b32 s88, s88, 6
    s_add_u32 s88, s88, 960
    v_mov_b32 v250, s88
    v_mov_b32 v254, s86
    v_cmp_gt_u32 vcc, 16, v0
    s_nop 1
    v_cndmask_b32 v250, v250, v254, vcc
    v_lshl_add_u32 v250, v0, 2, v250
    v_mov_b32 v254, s87
    v_cndmask_b32 v250, v250, v254, s[92:93]
    v_lshlrev_b32 v250, 5, v250
    v_or_b32 v250, s3, v250
    s_mov_b32 s10, 0xf00000
    v_mfma_f32_32x32x16_bf16 v[192:207], v[224:227], v[104:107], v[192:207]
    s_setprio 3
    ds_read_b64_tr_b16 v[232:233], v15 offset:40960
    ds_read_b64_tr_b16 v[234:235], v15 offset:41472
    v_mfma_f32_32x32x16_bf16 v[208:223], v[228:231], v[104:107], v[208:223]
    ds_read_b64_tr_b16 v[236:237], v15 offset:43008
    ds_read_b64_tr_b16 v[238:239], v15 offset:43520
    v_mfma_f32_16x16x32_bf16 v[244:247], v[28:31], v[228:231], v[244:247]
    s_waitcnt lgkmcnt(0)
    v_mfma_f32_32x32x16_bf16 v[192:207], v[232:235], v[108:111], v[192:207]
    ds_read_b64_tr_b16 v[224:225], v12 offset:57344
    ds_read_b64_tr_b16 v[226:227], v12 offset:57856
    v_mfma_f32_32x32x16_bf16 v[208:223], v[236:239], v[108:111], v[208:223]
    ds_read_b64_tr_b16 v[228:229], v12 offset:59392
    ds_read_b64_tr_b16 v[230:231], v12 offset:59904
    s_waitcnt lgkmcnt(0)
    v_mfma_f32_32x32x16_bf16 v[192:207], v[224:227], v[112:115], v[192:207]
    ds_read_b64_tr_b16 v[232:233], v13 offset:57344
    ds_read_b64_tr_b16 v[234:235], v13 offset:57856
    v_mfma_f32_32x32x16_bf16 v[208:223], v[228:231], v[112:115], v[208:223]
    ds_read_b64_tr_b16 v[236:237], v13 offset:59392
    ds_read_b64_tr_b16 v[238:239], v13 offset:59904
    v_mfma_f32_16x16x32_bf16 v[240:243], v[28:31], v[224:227], v[240:243]
    s_lshl_b32 s86, s63, 12
    v_add_u32 v32, s86, v1
    v_add_u32 v33, 0x10000, v32
    v_add_u32 v34, 0x20000, v32
    v_lshrrev_b32 v48, 5, v0
    v_bfe_u32 v9, v0, 2, 2
    v_lshl_add_u32 v9, v48, 2, v9
    v_lshlrev_b32 v9, 7, v9
    s_waitcnt lgkmcnt(0)
    v_mfma_f32_32x32x16_bf16 v[192:207], v[232:235], v[116:119], v[192:207]
    s_setprio 2
    ds_read_b64_tr_b16 v[224:225], v14 offset:57344
    ds_read_b64_tr_b16 v[226:227], v14 offset:57856
    v_mfma_f32_32x32x16_bf16 v[208:223], v[236:239], v[116:119], v[208:223]
    ds_read_b64_tr_b16 v[228:229], v14 offset:59392
    ds_read_b64_tr_b16 v[230:231], v14 offset:59904
    s_lshl_b32 s86, s78, 11
    v_add_u32 v35, 0, v10
    v_xor_b32 v35, v35, v11
    v_add3_u32 v35, v35, v9, s86
    v_add_u32 v36, 0x10000, v35
    v_add_u32 v37, 0x20000, v35
    v_xor_b32 v38, 64, v35
    v_xor_b32 v39, 64, v36
    v_xor_b32 v40, 64, v37
    s_waitcnt lgkmcnt(0)
    v_mfma_f32_32x32x16_bf16 v[192:207], v[224:227], v[120:123], v[192:207]
    ds_read_b64_tr_b16 v[232:233], v15 offset:57344
    ds_read_b64_tr_b16 v[234:235], v15 offset:57856
    v_mfma_f32_32x32x16_bf16 v[208:223], v[228:231], v[120:123], v[208:223]
    ds_read_b64_tr_b16 v[236:237], v15 offset:59392
    ds_read_b64_tr_b16 v[238:239], v15 offset:59904
    v_mfma_f32_16x16x32_bf16 v[244:247], v[28:31], v[228:231], v[244:247]
    s_lshr_b32 s86, s76, 1
    s_lshl_b32 s86, s86, 7
    s_add_u32 s86, s86, 2048
    v_min_u32 v41, 11, v0
    v_lshl_add_u32 v41, v41, 2, s86
    v_min_u32 v42, 27, v0
    v_lshl_add_u32 v42, v42, 2, s86
    v_lshlrev_b32 v41, 5, v41
    v_or_b32 v41, s3, v41
    v_lshlrev_b32 v42, 5, v42
    v_or_b32 v42, s3, v42
    v_add_u32 v12, 0x14000, v12
    s_waitcnt lgkmcnt(0)
    v_mfma_f32_32x32x16_bf16 v[192:207], v[232:235], v[124:127], v[192:207]
    s_setprio 1
    ds_read_b64_tr_b16 v[224:225], v12
    ds_read_b64_tr_b16 v[226:227], v12 offset:512
    v_mfma_f32_32x32x16_bf16 v[208:223], v[236:239], v[124:127], v[208:223]
    ds_read_b64_tr_b16 v[228:229], v12 offset:2048
    ds_read_b64_tr_b16 v[230:231], v12 offset:2560
    s_lshl_b32 s88, s76, 1
    s_add_u32 s88, s88, s79
    s_mul_i32 s75, s88, 112
    s_mul_i32 s87, s78, 12
    s_add_u32 s75, s75, s87
    s_lshl_b32 s75, s75, 10
    s_add_u32 s75, s75, 0x600000
    s_lshl_b32 s89, s78, 8
    s_add_u32 s89, s89, s88
    s_lshl_b32 s89, s89, 11
    s_cmp_ge_u32 s2, 224
    s_cselect_b32 s75, 0x70000000, s75
    s_cselect_b32 s89, 0x70000000, s89
    v_add_u32 v13, 0x14000, v13
    s_waitcnt lgkmcnt(0)
    s_cmp_eq_u32 s62, 0
    s_cbranch_scc0 L_G22
    buffer_load_dword v253, v250, s[40:43], s10 offen sc1
L_G22:
    v_mfma_f32_32x32x16_bf16 v[192:207], v[224:227], v[128:131], v[192:207]
    ds_read_b64_tr_b16 v[232:233], v13
    ds_read_b64_tr_b16 v[234:235], v13 offset:512
    v_mfma_f32_32x32x16_bf16 v[208:223], v[228:231], v[128:131], v[208:223]
    ds_read_b64_tr_b16 v[236:237], v13 offset:2048
    ds_read_b64_tr_b16 v[238:239], v13 offset:2560
    v_mfma_f32_16x16x32_bf16 v[240:243], v[28:31], v[224:227], v[240:243]
    v_lshrrev_b32 v48, 3, v0
    s_lshl_b32 s86, s62, 3
    v_add_u32 v48, s86, v48
    v_and_b32 v49, 7, v0
    v_mul_u32_u24 v43, 896, v48
    v_lshl_add_u32 v43, v49, 4, v43
    v_mul_u32_u24 v44, 272, v48
    v_lshl_add_u32 v44, v49, 5, v44
    s_mul_i32 s91, s76, 57344
    s_lshl_b32 s86, s77, 7
    s_add_u32 s91, s91, s86
    v_add_u32 v14, 0x14000, v14
    s_waitcnt lgkmcnt(0)
    v_mfma_f32_32x32x16_bf16 v[192:207], v[232:235], v[132:135], v[192:207]
    ds_read_b64_tr_b16 v[224:225], v14
    ds_read_b64_tr_b16 v[226:227], v14 offset:512
    v_mfma_f32_32x32x16_bf16 v[208:223], v[236:239], v[132:135], v[208:223]
    ds_read_b64_tr_b16 v[228:229], v14 offset:2048
    ds_read_b64_tr_b16 v[230:231], v14 offset:2560
    v_and_b32 v45, 31, v0
    v_mul_u32_u24 v45, 272, v45
    v_lshrrev_b32 v48, 5, v0
    v_lshl_add_u32 v45, v48, 4, v45
    s_mul_i32 s86, s62, 8704
    v_add_u32 v45, s86, v45
    s_lshl_b32 s11, s71, 6
    s_add_u32 s11, s11, s82
    s_lshl_b32 s11, s11, 11
    s_lshl_b32 s101, s63, 10
    s_add_u32 s101, s101, s11
    v_add_u32 v15, 0x14000, v15
    s_waitcnt lgkmcnt(0)
    v_mfma_f32_32x32x16_bf16 v[192:207], v[224:227], v[136:139], v[192:207]
    s_setprio 0
    ds_read_b64_tr_b16 v[232:233], v15
    ds_read_b64_tr_b16 v[234:235], v15 offset:512
    v_mfma_f32_32x32x16_bf16 v[208:223], v[228:231], v[136:139], v[208:223]
    ds_read_b64_tr_b16 v[236:237], v15 offset:2048
    ds_read_b64_tr_b16 v[238:239], v15 offset:2560
    v_mfma_f32_16x16x32_bf16 v[244:247], v[28:31], v[228:231], v[244:247]
    s_lshl_b32 s86, s64, 2
    s_lshl_b32 s87, s63, 9
    s_sub_u32 s86, s86, s87
    s_add_u32 s86, s86, 3072
    v_add_u32 v249, s86, v249
    s_waitcnt lgkmcnt(0)
    v_mfma_f32_32x32x16_bf16 v[192:207], v[232:235], v[140:143], v[192:207]
    ds_write_b32 v249, v240
    v_mfma_f32_32x32x16_bf16 v[208:223], v[236:239], v[140:143], v[208:223]
    ds_write_b32 v249, v244 offset:512
    v_and_b32 v249, 0xfffffff0, v249
    s_branch L_JOIN
L_HOT_END:
L_SLOW:
    s_waitcnt vmcnt(0) lgkmcnt(0)
    v_cndmask_b32 v150, v150, 0, s[92:93]
    v_mov_b32 v48, 0xff800000
    s_mov_b32 s73, s81
    s_mov_b32 s87, 64
L_SLOW1:
    buffer_load_dwordx4 v[96:99], v1, s[40:43], s73 offen sc1
    buffer_load_dwordx4 v[100:103], v1, s[40:43], s73 offen offset:1024 sc1
    s_waitcnt vmcnt(1)
    v_mfma_f32_32x32x16_bf16 v[56:71], v[96:99], v[144:147], 0
    s_waitcnt vmcnt(0)
    v_mfma_f32_32x32x16_bf16 v[56:71], v[100:103], v[148:151], v[56:71]
    s_nop 11
    v_max3_f32 v48, v48, v56, v57
    v_max3_f32 v48, v48, v58, v59
    v_max3_f32 v48, v48, v60, v61
    v_max3_f32 v48, v48, v62, v63
    v_max3_f32 v48, v48, v64, v65
    v_max3_f32 v48, v48, v66, v67
    v_max3_f32 v48, v48, v68, v69
    v_max3_f32 v48, v48, v70, v71
    s_add_u32 s73, s73, 4096
    s_sub_u32 s87, s87, 1
    s_cmp_lg_u32 s87, 0
    s_cbranch_scc1 L_SLOW1
    v_mov_b32 v49, v48
    s_nop 1
    v_permlane32_swap_b32 v48, v49
    v_max_f32 v48, v48, v49
    v_mov_b32 v12, 0
    v_mov_b32 v13, 0
    v_mov_b32 v14, 0
    v_mov_b32 v15, 0
    v_mov_b32 v16, 0
    v_mov_b32 v17, 0
    v_mov_b32 v18, 0
    v_mov_b32 v19, 0
    v_mov_b32 v20, 0
    v_mov_b32 v21, 0
    v_mov_b32 v22, 0
    v_mov_b32 v23, 0
    v_mov_b32 v24, 0
    v_mov_b32 v25, 0
    v_mov_b32 v26, 0
    v_mov_b32 v27, 0
    s_mov_b32 s73, s81
    s_mov_b32 s87, 64
L_SLOW2:
    buffer_load_dwordx4 v[96:99], v1, s[40:43], s73 offen sc1
    buffer_load_dwordx4 v[100:103], v1, s[40:43], s73 offen offset:1024 sc1
    buffer_load_dwordx4 v[104:107], v1, s[40:43], s73 offen offset:2048 sc1
    buffer_load_dwordx4 v[108:111], v1, s[40:43], s73 offen offset:3072 sc1
    s_waitcnt vmcnt(3)
    v_mfma_f32_32x32x16_bf16 v[56:71], v[96:99], v[144:147], 0
    s_waitcnt vmcnt(2)
    v_mfma_f32_32x32x16_bf16 v[56:71], v[100:103], v[148:151], v[56:71]
    s_nop 11
    v_sub_f32 v56, v56, v48
    v_sub_f32 v57, v57, v48
    v_sub_f32 v58, v58, v48
    v_sub_f32 v59, v59, v48
    v_sub_f32 v60, v60, v48
    v_sub_f32 v61, v61, v48
    v_sub_f32 v62, v62, v48
    v_sub_f32 v63, v63, v48
    v_sub_f32 v64, v64, v48
    v_sub_f32 v65, v65, v48
    v_sub_f32 v66, v66, v48
    v_sub_f32 v67, v67, v48
    v_sub_f32 v68, v68, v48
    v_sub_f32 v69, v69, v48
    v_sub_f32 v70, v70, v48
    v_sub_f32 v71, v71, v48
    v_exp_f32 v56, v56
    v_exp_f32 v57, v57
    v_exp_f32 v58, v58
    v_exp_f32 v59, v59
    v_exp_f32 v60, v60
    v_exp_f32 v61, v61
    v_exp_f32 v62, v62
    v_exp_f32 v63, v63
    v_exp_f32 v64, v64
    v_exp_f32 v65, v65
    v_exp_f32 v66, v66
    v_exp_f32 v67, v67
    v_exp_f32 v68, v68
    v_exp_f32 v69, v69
    v_exp_f32 v70, v70
    v_exp_f32 v71, v71
    v_cvt_pk_bf16_f32 v88, v56, v57
    v_cvt_pk_bf16_f32 v89, v58, v59
    v_cvt_pk_bf16_f32 v90, v60, v61
    v_cvt_pk_bf16_f32 v91, v62, v63
    v_cvt_pk_bf16_f32 v92, v64, v65
    v_cvt_pk_bf16_f32 v93, v66, v67
    v_cvt_pk_bf16_f32 v94, v68, v69
    v_cvt_pk_bf16_f32 v95, v70, v71
    s_waitcnt vmcnt(1)
    v_mfma_f32_32x32x16_bf16 v[12:27], v[104:107], v[88:91], v[12:27]
    s_waitcnt vmcnt(0)
    v_mfma_f32_32x32x16_bf16 v[12:27], v[108:111], v[92:95], v[12:27]
    s_add_u32 s73, s73, 4096
    s_sub_u32 s87, s87, 1
    s_cmp_lg_u32 s87, 0
    s_cbranch_scc1 L_SLOW2
    s_nop 15
    v_mov_b32 v48, v24
    v_mov_b32 v49, v24
    s_nop 1
    v_permlane32_swap_b32 v48, v49
    s_cmp_eq_u32 s63, 0
    s_cbranch_scc1 L_NOSWAP2
    v_swap_b32 v12, v20
    v_swap_b32 v13, v21
    v_swap_b32 v14, v22
    v_swap_b32 v15, v23
    v_swap_b32 v16, v24
    v_swap_b32 v17, v25
    v_swap_b32 v18, v26
    v_swap_b32 v19, v27
L_NOSWAP2:
    v_mul_f32 v48, 0x45800000, v49
    v_rcp_f32 v52, v48
    s_nop 0
    v_mul_f32 v52, 0x39800000, v52
    v_cndmask_b32 v53, v52, 0, s[94:95]
    v_mul_f32 v12, v12, v52
    v_mul_f32 v13, v13, v52
    v_mul_f32 v14, v14, v52
    v_mul_f32 v15, v15, v52
    v_mul_f32 v16, v16, v53
    v_mul_f32 v17, v17, v52
    v_mul_f32 v18, v18, v52
    v_mul_f32 v19, v19, v52
    s_branch L_FIN
.section .rodata,"a"
.p2align 6
.amdhsa_kernel parallel_sum__mha_block__geglu_ffn__prompt_kernel
  .amdhsa_next_free_vgpr 256
  .amdhsa_next_free_sgpr 102
  .amdhsa_accum_offset 256
  .amdhsa_group_segment_fixed_size 0
  .amdhsa_kernarg_size 80
  .amdhsa_user_sgpr_count 2
  .amdhsa_user_sgpr_kernarg_segment_ptr 1
  .amdhsa_system_sgpr_workgroup_id_x 1
.end_amdhsa_kernel
```
